```python
import torch

def _softmax(x, axis=-1):
    return torch.softmax(x, dim=axis)

def _gelu(x):
    return torch.nn.functional.gelu(x, approximate='tanh')

def _silu(x):
    return torch.nn.functional.silu(x)

def _sigmoid(x):
    return torch.sigmoid(x)

def _layernorm(x, axis=-1, eps=1e-05):
    m = x.mean(dim=axis, keepdim=True)
    v = x.var(dim=axis, keepdim=True, unbiased=False)
    return (x - m) / torch.sqrt(v + eps)

def _scatter_add(tgt, idx, src, axis=0):
    return tgt.clone().index_add_(axis, idx, src)

def _segment_sum(src, seg, n):
    out = torch.zeros((n,) + src.shape[1:], dtype=src.dtype)
    return out.index_add_(0, seg, src)

def _pad(x, pw):
    flat = tuple((v for pair in reversed(pw) for v in pair))
    return torch.nn.functional.pad(x, flat)
kernel_name = 'adaLN_cond__sliding_local_dilated__glu_gated_bilinear__prompt'

def setup_inputs():

    _w = lambda a: (lambda t: t.to(torch.bfloat16) if t.is_floating_point() else t)(torch.as_tensor(a))

    def _A_setup():
        B, S, D = (1, 2048, 640)
        return {'x': _w((lambda *s: torch.randn(*s, dtype=torch.bfloat16) * 0.05)(B, S, D)), 'wqkv': _w((lambda *s: torch.randn(*s, dtype=torch.bfloat16) * 0.05)(D, 3 * D)), 'wo': _w((lambda *s: torch.randn(*s, dtype=torch.bfloat16) * 0.05)(D, D))}
    _A_in = _A_setup()

    def _B_setup():
        B, S, D, F = (1, 2048, 640, 1728)
        return {'x': _w((lambda *s: torch.randn(*s, dtype=torch.bfloat16) * 0.05)(B, S, D)), 'w_gate': _w((lambda *s: torch.randn(*s, dtype=torch.bfloat16) * 0.8)(D, F) * D ** (-0.5)), 'w_up': _w((lambda *s: torch.randn(*s, dtype=torch.bfloat16) * 0.8)(D, F) * D ** (-0.5)), 'w_down': _w((lambda *s: torch.randn(*s, dtype=torch.bfloat16) * 0.8)(F, D) * F ** (-0.5))}
    _B_in = _B_setup()
    return {'A_x': _A_in['x'], 'A_wqkv': _A_in['wqkv'], 'A_wo': _A_in['wo'], 'B_x': _B_in['x'], 'B_w_gate': _B_in['w_gate'], 'B_w_up': _B_in['w_up'], 'B_w_down': _B_in['w_down'], 'c': _w((lambda *s: torch.randn(*s, dtype=torch.bfloat16) * 0.1)(1, 640) * 8.0), 'w_mod': _w((lambda *s: torch.randn(*s, dtype=torch.bfloat16) * 0.1)(640, 6 * 640) * 640 ** (-0.5) * 8.0)}

def reference(A_x, A_wqkv, A_wo, B_x, B_w_gate, B_w_up, B_w_down, c, w_mod):

    def _A_ref(x, wqkv, wo):
        B, S, D = x.shape
        H = 32
        Dh = D // H
        W, dil = (8, 2)
        qkv = (lambda x, *d: x.permute(*d))((x @ wqkv).reshape(B, S, 3, H, Dh), 2, 0, 3, 1, 4)
        q, k, v = (qkv[0], qkv[1], qkv[2])
        scale = Dh ** (-0.5)
        pos = torch.arange(S)
        off = torch.arange(W) * dil
        idx = pos[:, None] - off[None, :]
        mask = idx >= 0
        idx_c = torch.where(mask, idx, 0).reshape(-1)
        kg = k[:, :, idx_c, :].reshape(B, H, S, W, Dh)
        vg = v[:, :, idx_c, :].reshape(B, H, S, W, Dh)
        logits = torch.einsum('bhsd,bhswd->bhsw', q, kg) * scale
        logits = torch.where(mask[None, None, :, :], logits, -1000000000.0)
        attn = _softmax(logits, axis=-1)
        o = torch.einsum('bhsw,bhswd->bhsd', attn, vg)
        return (lambda x, *d: x.permute(*d))(o, 0, 2, 1, 3).reshape(B, S, D) @ wo

    def _B_ref(x, w_gate, w_up, w_down):
        g = torch.einsum('bsd,df->bsf', x, w_gate)
        u = torch.einsum('bsd,df->bsf', x, w_up)
        h = g * u
        return torch.einsum('bsf,fd->bsd', h, w_down)
    x = A_x
    mod = (_silu(c) @ w_mod).reshape(c.shape[0], 6, 1, -1)
    sa, ca, ga, sb, cb, gb = (mod[:, 0].clone(), mod[:, 1].clone(), mod[:, 2].clone(), mod[:, 3].clone(), mod[:, 4].clone(), mod[:, 5].clone())
    h = _layernorm(x, axis=-1) * (1 + ca) + sa
    x = x + ga * _A_ref(h, A_wqkv, A_wo)
    h = _layernorm(x, axis=-1) * (1 + cb) + sb
    x = x + gb * _B_ref(h, B_w_gate, B_w_up, B_w_down)
    return x
```

```asm
; @launch grid=(256,1,1) block=(256,1,1) lds=163840
.amdgcn_target "amdgcn-amd-amdhsa--gfx950"
.text
.globl adaLN_cond__sliding_local_dilated__glu_gated_bilinear__prompt_kernel
.p2align 8
.type adaLN_cond__sliding_local_dilated__glu_gated_bilinear__prompt_kernel,@function
adaLN_cond__sliding_local_dilated__glu_gated_bilinear__prompt_kernel:
    s_cmp_ge_u32 s2, 256
    s_cbranch_scc1 L_end
    s_load_dwordx16 s[4:19], s[0:1], 0
    s_load_dwordx8 s[20:27], s[0:1], 64
    s_getpc_b64 s[86:87]
    s_lshr_b32 s77, s2, 3
    s_lshl_b32 s76, s77, 11
    v_lshl_add_u32 v31, v0, 3, s76
    s_cmp_ge_u32 s2, 192
    s_cbranch_scc1 L_nocode
    global_load_dword v254, v31, s[86:87]
L_nocode:
    v_lshrrev_b32 v24, 6, v0
    v_lshrrev_b32 v220, 3, v0
    v_readfirstlane_b32 s60, v24
    s_and_b32 s76, s2, 7
    s_lshr_b32 s61, s76, 1
    s_lshl_b32 s61, s61, 2
    s_lshr_b32 s78, s77, 3
    s_add_u32 s61, s61, s78
    s_and_b32 s62, s76, 1
    s_lshl_b32 s62, s62, 3
    s_and_b32 s78, s77, 7
    s_add_u32 s62, s62, s78
    s_lshl_b32 s63, s61, 4
    s_add_u32 s63, s63, s62
    s_mul_i32 s83, s63, 10240
    v_mov_b32 v61, 1073741824
    v_lshrrev_b32 v223, 5, v0
    v_and_b32 v222, 31, v0
    v_mul_u32_u24 v204, 1280, v223
    v_cmp_gt_u32 vcc, 16, v222
    v_lshl_add_u32 v204, v222, 4, v204
    v_and_b32 v221, 7, v0
    v_cndmask_b32 v205, v61, v204, vcc
    v_lshlrev_b32 v221, 4, v221
    v_mul_u32_u24 v200, 7680, v220
    v_add_u32 v200, v200, v221
    v_lshlrev_b32 v86, 1, v0
    s_and_b32 s88, s2, 3
    s_mul_i32 s79, s88, 1228768
    s_lshl_b32 s78, s2, 5
    s_add_u32 s79, s79, s78
    s_mul_i32 s81, s88, 320
    s_lshl_b32 s75, s60, 10
    s_cmp_lt_u32 s2, 240
    s_cselect_b32 s42, 4915200, 0
    s_mov_b32 s43, 0x20000
    s_mov_b32 s46, 1280
    s_mov_b32 s47, 0x20000
    s_mov_b32 s30, 2621440
    s_mov_b32 s31, 0x20000
    s_mov_b32 s51, 0x20000
    s_and_b32 s97, s77, 7
    s_and_b32 s77, s77, 24
    s_add_u32 s85, s77, s76
    s_cmp_lt_u32 s85, 30
    s_cselect_b32 s50, 2457600, 0
    s_add_u32 m0, s75, 0
    s_waitcnt lgkmcnt(0)
    s_cmp_lg_u32 s2, 255
    s_cbranch_scc1 L_noprobe_1
    s_cmp_lg_u32 s60, 0
    s_cbranch_scc1 L_probed_2
    s_mov_b64 s[32:33], s[26:27]
    s_mov_b32 s34, 55574528
    s_mov_b32 s35, 0x20000
    s_mov_b64 s[36:37], s[24:25]
    s_mov_b32 s38, 256
    s_mov_b32 s39, 0x20000
    v_lshlrev_b32 v25, 2, v0
    v_mov_b32 v26, 0
    s_mov_b32 s84, 0
    s_mov_b32 s52, 1572864
    s_mov_b32 s53, 1581056
    buffer_store_dword v26, v25, s[32:35], s52 offen sc1
    buffer_store_dword v26, v25, s[32:35], s53 offen sc1
    s_waitcnt vmcnt(1)
    s_memtime s[54:55]
    s_waitcnt vmcnt(0)
    s_memtime s[56:57]
    s_waitcnt lgkmcnt(0)
    s_sub_u32 s56, s56, s54
    s_min_u32 s56, s56, 400
    s_add_u32 s84, s84, s56
    buffer_store_dword v26, v25, s[32:35], s53 offen sc1
    buffer_store_dword v26, v25, s[32:35], s52 offen sc1
    s_waitcnt vmcnt(1)
    s_memtime s[54:55]
    s_waitcnt vmcnt(0)
    s_memtime s[56:57]
    s_waitcnt lgkmcnt(0)
    s_sub_u32 s56, s56, s54
    s_min_u32 s56, s56, 400
    s_sub_u32 s84, s84, s56
    s_cmp_gt_i32 s84, 0
    s_cselect_b32 s84, 2, 1
    v_mov_b32 v26, s84
    buffer_store_dword v26, v25, s[36:39], 0 offen sc1
L_probed_2:
    s_barrier
L_noprobe_1:
    s_mov_b64 s[44:45], s[18:19]
    s_mov_b64 s[40:41], s[20:21]
    buffer_load_ushort v202, v86, s[44:47], s81 offen
    buffer_load_dwordx4 v200, s[40:43], s79 offen nt lds
    s_add_u32 m0, m0, 4096
    s_add_u32 s79, s79, 245760
    buffer_load_dwordx4 v200, s[40:43], s79 offen nt lds
    s_add_u32 m0, m0, 4096
    s_add_u32 s79, s79, 245760
    buffer_load_dwordx4 v200, s[40:43], s79 offen nt lds
    s_add_u32 m0, m0, 4096
    s_add_u32 s79, s79, 245760
    buffer_load_dwordx4 v200, s[40:43], s79 offen nt lds
    s_add_u32 m0, m0, 4096
    s_add_u32 s79, s79, 245760
    buffer_load_dwordx4 v200, s[40:43], s79 offen nt lds
    s_load_dword s64, s[26:27], 0
    s_mov_b64 s[46:47], s[24:25]
    s_branch L_page0
    .p2align 12
L_page0:
    s_mov_b64 exec, 0
    s_cmp_eq_u32 s60, 0
    s_cbranch_scc1 L_pad0
    s_cmp_eq_u32 s60, 1
    s_cbranch_scc1 L_pad1
    s_cmp_eq_u32 s60, 2
    s_cbranch_scc1 L_pad2
    s_branch L_pad3
L_hopped:
    s_mov_b64 exec, -1
    s_mov_b64 s[28:29], s[4:5]
    buffer_load_dwordx4 v[208:211], v204, s[28:31], s83 offen
    buffer_load_dwordx4 v[212:215], v204, s[28:31], s83 offen offset:512
    buffer_load_dwordx4 v[216:219], v205, s[28:31], s83 offen offset:1024
    s_min_u32 s76, s85, 29
    s_mul_i32 s96, s76, 6554
    s_lshr_b32 s96, s96, 16
    s_mul_i32 s95, s96, 10
    s_sub_u32 s95, s76, s95
    s_mul_i32 s82, s95, 245760
    s_mul_i32 s77, s96, 1280
    s_add_u32 s82, s82, s77
    s_mul_i32 s77, s97, 160
    s_add_u32 s82, s82, s77
    s_mov_b64 s[48:49], s[6:7]
    v_add_u32 v31, 0, v0
    v_mul_u32_u24 v32, 6554, v31
    v_lshrrev_b32 v32, 16, v32
    v_mul_u32_u24 v33, 10, v32
    v_sub_u32 v33, v31, v33
    v_mul_u32_u24 v201, 3840, v32
    s_add_u32 m0, s75, 20480
    v_lshl_add_u32 v201, v33, 4, v201
    buffer_load_dwordx4 v201, s[48:51], s82 offen nt lds
    v_add_u32 v31, 256, v0
    v_mul_u32_u24 v32, 6554, v31
    v_lshrrev_b32 v32, 16, v32
    v_mul_u32_u24 v33, 10, v32
    v_sub_u32 v33, v31, v33
    v_mul_u32_u24 v201, 3840, v32
    s_add_u32 m0, s75, 24576
    v_lshl_add_u32 v201, v33, 4, v201
    buffer_load_dwordx4 v201, s[48:51], s82 offen nt lds
    v_add_u32 v31, 512, v0
    v_mul_u32_u24 v32, 6554, v31
    v_lshrrev_b32 v32, 16, v32
    v_mul_u32_u24 v33, 10, v32
    v_sub_u32 v33, v31, v33
    v_mul_u32_u24 v201, 3840, v32
    v_cmp_gt_u32 vcc, 64, v32
    s_add_u32 m0, s75, 28672
    v_lshl_add_u32 v201, v33, 4, v201
    v_cndmask_b32 v201, v61, v201, vcc
    buffer_load_dwordx4 v201, s[48:51], s82 offen nt lds
    v_and_b32 v1, 63, v0
    v_lshlrev_b32 v2, 4, v1
    v_lshrrev_b32 v5, 4, v1
    v_and_b32 v6, 15, v1
    v_bfe_u32 v62, v1, 2, 2
    v_and_b32 v63, 3, v1
    v_lshl_add_u32 v87, v5, 3, v62
    v_lshlrev_b32 v100, 4, v5
    v_lshlrev_b32 v101, 5, v5
    s_and_b32 s74, s62, 7
    s_lshl_b32 s72, s61, 3
    s_lshr_b32 s78, s62, 3
    s_lshl_b32 s78, s78, 2
    s_add_u32 s73, s72, s78
    s_add_u32 s73, s73, s60
    s_lshl_b32 s78, s60, 1
    s_add_u32 s72, s72, s78
    s_lshl_b32 s76, s60, 5
    v_lshl_add_u32 v92, v87, 7, s76
    v_lshl_add_u32 v92, v63, 3, v92
    s_lshl_b32 s76, s60, 7
    v_add_u32 v93, s76, v101
    v_cmp_gt_u32 vcc, 2, v6
    v_lshl_add_u32 v93, v6, 4, v93
    s_lshl_b32 s19, s2, 9
    s_add_u32 s19, s19, 1114112
    v_cndmask_b32 v93, v61, v93, vcc
    s_mov_b64 s[32:33], s[26:27]
    s_mov_b32 s34, 55574528
    s_mov_b32 s35, 0x20000
    s_mov_b64 s[36:37], s[22:23]
    s_mov_b32 s38, 2621440
    s_mov_b32 s39, 0x20000
    s_mov_b64 s[56:57], s[16:17]
    s_mov_b32 s58, 2211840
    s_mov_b32 s59, 0x20000
    s_mul_i32 s92, s2, 607
    s_lshr_b32 s92, s92, 16
    s_mul_i32 s76, s92, 108
    s_sub_u32 s76, s2, s76
    s_lshr_b32 s89, s76, 2
    s_cmp_lt_u32 s2, 108
    s_cselect_b64 s[52:53], s[12:13], s[14:15]
    s_cmp_lt_u32 s2, 216
    s_cselect_b64 s[52:53], s[52:53], s[8:9]
    s_cselect_b64 s[86:87], -1, 0
    s_mov_b32 s20, 1280
    s_cselect_b32 s20, 3456, s20
    s_mul_i32 s54, s20, 640
    s_mov_b32 s55, 0x20000
    s_mov_b64 s[4:5], s[26:27]
    s_cmp_lt_u32 s2, 240
    s_cselect_b32 s6, 55574528, 0
    s_mov_b32 s7, 0x20000
    s_mov_b64 s[8:9], s[26:27]
    s_cmp_lt_u32 s85, 30
    s_cselect_b32 s10, 55574528, 0
    s_mov_b32 s11, 0x20000
    s_mov_b64 s[12:13], s[26:27]
    s_cmp_ge_u32 s2, 76
    s_cselect_b32 s14, 55574528, 0
    s_mov_b32 s15, 0x20000
    s_cselect_b32 s58, s58, 0
    s_max_u32 s76, s2, 76
    s_sub_u32 s76, s76, 76
    s_mul_i32 s91, s76, 3641
    s_lshr_b32 s91, s91, 16
    s_mul_i32 s90, s91, 18
    s_sub_u32 s90, s76, s90
    v_mul_u32_u24 v253, 1280, v220
    v_add_u32 v253, v253, v221
    v_mul_lo_u32 v252, v220, s20
    v_add_u32 v252, v252, v221
    s_mul_i32 s22, s88, 160
    s_mul_i32 s22, s22, s20
    s_lshl_b32 s77, s89, 7
    s_add_u32 s22, s22, s77
    s_lshl_b32 s20, s20, 5
    s_mul_i32 s23, s90, 122880
    s_lshl_b32 s77, s91, 7
    s_add_u32 s23, s23, s77
    s_mul_i32 s76, s2, 1280
    s_add_u32 s76, s76, 65536
    v_lshlrev_b32 v24, 7, v0
    v_cmp_gt_u32 vcc, 10, v0
    s_nop 1
    v_cndmask_b32 v24, v61, v24, vcc
    buffer_load_dword v199, v24, s[32:35], s76 offen sc1
    s_waitcnt vmcnt(12)
    v_lshlrev_b32 v202, 16, v202
    v_mul_f32 v203, 0xbfb8aa3b, v202
    v_exp_f32 v203, v203
    s_nop 0
    v_add_f32 v203, 1.0, v203
    v_rcp_f32 v203, v203
    s_nop 0
    v_mul_f32 v202, v202, v203
    v_cvt_pk_bf16_f32 v202, v202, v202
    ds_write_b16 v86, v202 offset:47104
    s_add_u32 m0, s75, 50176
    s_nop 0
    buffer_load_dwordx4 v252, s[52:55], s22 offen nt lds
    v_mul_u32_u24 v88, 144, v222
    v_lshl_add_u32 v88, v223, 4, v88
    v_mul_u32_u24 v89, 144, v220
    v_add_u32 v89, v89, v221
    v_lshl_add_u32 v90, v220, 8, v221
    v_cmp_gt_u32 vcc, 16, v220
    s_lshr_b32 s76, s62, 1
    s_mul_i32 s24, s76, 49152
    v_cndmask_b32 v91, v61, v90, vcc
    s_and_b32 s77, s63, 1
    s_lshl_b32 s77, s77, 7
    s_add_u32 s24, s24, s77
    s_add_u32 m0, s75, 54272
    s_add_u32 s22, s22, s20
    buffer_load_dwordx4 v252, s[52:55], s22 offen nt lds
    v_mul_u32_u24 v26, 160, v87
    s_mul_i32 s76, s60, 40
    v_lshl_add_u32 v95, v63, 3, v26
    v_add_u32 v95, s76, v95
    v_mad_u32_u24 v96, v63, 40, v26
    s_lshr_b32 s76, s60, 1
    s_mul_i32 s76, s76, 10
    s_add_u32 s76, s76, s95
    s_lshl_b32 s76, s76, 11
    s_and_b32 s77, s60, 1
    s_lshl_b32 s77, s77, 8
    s_add_u32 s76, s76, s77
    s_add_u32 s25, s76, 1114112
    v_lshlrev_b32 v26, 4, v6
    v_lshl_add_u32 v97, v5, 9, v26
    s_lshl_b32 s76, s60, 6
    v_lshl_add_u32 v98, v6, 2, s76
    v_lshlrev_b32 v99, 1, v98
    s_lshl_b32 s81, s97, 1
    s_lshl_b32 s76, s96, 2
    s_lshr_b32 s76, 0x402, s76
    s_and_b32 s76, s76, 15
    s_and_b32 s77, s60, 1
    s_add_u32 s76, s76, s77
    s_lshr_b32 s77, s60, 1
    s_add_u32 s77, s77, s81
    s_cmp_eq_u32 s96, 2
    s_cselect_b32 s78, 7, 6
    s_cmp_eq_u32 s96, 0
    s_cselect_b32 s79, 128, 0
    s_lshl_b32 s16, s77, 19
    s_lshl_b32 s83, s76, 10
    s_add_u32 s16, s16, s83
    s_lshl_b32 s17, s95, 14
    s_add_u32 s17, s17, 18874368
    s_add_u32 s16, s16, s17
    s_lshl_b32 s83, s81, 19
    s_add_u32 s17, s17, s83
    s_lshl_b32 s83, s78, 10
    s_add_u32 s17, s17, s83
    s_add_u32 s17, s17, s79
    s_lshl_b32 s18, s96, 3
    s_add_u32 s18, s18, s97
    s_mul_i32 s18, s18, 10
    s_add_u32 s18, s18, s95
    s_mul_i32 s18, s18, 320
    s_lshl_b32 s76, s60, 6
    s_add_u32 s18, s18, s76
    s_add_u32 s18, s18, 1310720
    v_lshrrev_b32 v102, 3, v6
    v_cmp_eq_u32 vcc, 0, v6
    v_mul_u32_u24 v102, 524160, v102
    v_add_u32 v102, v102, v2
    v_cndmask_b32 v85, v61, v100, vcc
    s_add_u32 m0, s75, 58368
    s_add_u32 s22, s22, s20
    buffer_load_dwordx4 v252, s[52:55], s22 offen nt lds
    v_and_b32 v24, 127, v0
    v_min_u32 v24, 119, v24
    v_lshlrev_b32 v24, 1, v24
    s_mul_i32 s76, s88, 160
    s_mul_i32 s77, s74, 80
    s_cmp_lt_u32 s60, 2
    s_cselect_b32 s81, 4, 3
    s_cselect_b32 s82, 2, 5
    s_mul_i32 s81, s81, 640
    s_mul_i32 s82, s82, 640
    s_add_u32 s76, s76, s81
    s_add_u32 s77, s77, s82
    s_sub_u32 s77, s77, 160
    v_cmp_gt_u32 vcc, 160, v24
    v_add_u32 v26, s76, v24
    v_add_u32 v27, s77, v24
    v_cndmask_b32 v26, v27, v26, vcc
    v_lshrrev_b32 v27, 6, v26
    v_and_b32 v26, 63, v26
    v_lshlrev_b32 v27, 11, v27
    v_lshl_add_u32 v120, v26, 3, v27
    v_add_u32 v120, 1114112, v120
    s_add_u32 m0, s75, 62464
    s_add_u32 s22, s22, s20
    buffer_load_dwordx4 v252, s[52:55], s22 offen nt lds
    v_lshlrev_b32 v25, 2, v1
    v_cmp_gt_u32 vcc, 32, v0
    s_lshl_b32 s76, s85, 3
    s_add_u32 s76, s76, s97
    v_lshl_add_u32 v24, s62, 7, v25
    v_cndmask_b32 v11, v61, v24, vcc
    v_lshl_add_u32 v24, s2, 7, v25
    v_cndmask_b32 v103, v61, v24, vcc
    v_lshl_add_u32 v24, s76, 7, v25
    v_cndmask_b32 v94, v61, v24, vcc
    v_cmp_gt_u32 vcc, 32, v1
    s_lshl_b32 s78, s62, 2
    s_add_u32 s78, s78, s60
    v_lshl_add_u32 v24, s78, 7, v25
    v_cndmask_b32 v60, v61, v24, vcc
    s_waitcnt vmcnt(11)
    s_waitcnt lgkmcnt(0)
    s_barrier
    ds_read_b128 v[148:151], v100 offset:47104
    ds_read_b64_tr_b16 v[128:129], v92 offset:0
    ds_read_b64_tr_b16 v[130:131], v92 offset:512
    ds_read_b128 v[152:155], v100 offset:47168
    ds_read_b64_tr_b16 v[132:133], v92 offset:4096
    ds_read_b64_tr_b16 v[134:135], v92 offset:4608
    ds_read_b128 v[156:159], v100 offset:47232
    ds_read_b64_tr_b16 v[136:137], v92 offset:8192
    ds_read_b64_tr_b16 v[138:139], v92 offset:8704
    ds_read_b128 v[160:163], v100 offset:47296
    ds_read_b64_tr_b16 v[140:141], v92 offset:12288
    ds_read_b64_tr_b16 v[142:143], v92 offset:12800
    ds_read_b128 v[164:167], v100 offset:47360
    ds_read_b64_tr_b16 v[144:145], v92 offset:16384
    ds_read_b64_tr_b16 v[146:147], v92 offset:16896
    s_add_u32 s64, s64, 0x9e3779b1
    v_mov_b32 v22, s64
    s_waitcnt lgkmcnt(12)
    v_mfma_f32_16x16x32_bf16 v[168:171], v[128:131], v[148:151], 0
    s_waitcnt lgkmcnt(9)
    v_mfma_f32_16x16x32_bf16 v[168:171], v[132:135], v[152:155], v[168:171]
    s_waitcnt lgkmcnt(6)
    v_mfma_f32_16x16x32_bf16 v[168:171], v[136:139], v[156:159], v[168:171]
    s_waitcnt lgkmcnt(3)
    v_mfma_f32_16x16x32_bf16 v[168:171], v[140:143], v[160:163], v[168:171]
    s_waitcnt lgkmcnt(0)
    v_mfma_f32_16x16x32_bf16 v[168:171], v[144:147], v[164:167], v[168:171]
    v_cmp_eq_u32 vcc, 0, v6
    v_mov_b32 v173, s64
    v_mov_b32 v175, s64
    s_nop 4
    v_cndmask_b32 v172, v170, v168, vcc
    v_cndmask_b32 v174, v171, v169, vcc
    buffer_store_dwordx4 v[172:175], v93, s[4:7], s19 offen sc1
    s_load_dword s44, s[46:47], 0
    s_add_u32 m0, s75, 66560
    s_add_u32 s22, s22, s20
    buffer_load_dwordx4 v252, s[52:55], s22 offen nt lds
    s_add_u32 m0, s75, 70656
    s_add_u32 s76, s23, 0
    buffer_load_dwordx4 v253, s[56:59], s76 offen nt lds
    s_add_u32 m0, s75, 74752
    s_add_u32 s76, s23, 40960
    buffer_load_dwordx4 v253, s[56:59], s76 offen nt lds
    s_add_u32 m0, s75, 78848
    s_add_u32 s76, s23, 81920
    buffer_load_dwordx4 v253, s[56:59], s76 offen nt lds
    s_waitcnt vmcnt(13)
    v_lshlrev_b32 v128, 16, v208
    v_and_b32 v129, 0xffff0000, v208
    v_lshlrev_b32 v130, 16, v209
    v_and_b32 v131, 0xffff0000, v209
    v_lshlrev_b32 v132, 16, v210
    v_and_b32 v133, 0xffff0000, v210
    v_lshlrev_b32 v134, 16, v211
    v_and_b32 v135, 0xffff0000, v211
    v_lshlrev_b32 v136, 16, v212
    v_and_b32 v137, 0xffff0000, v212
    v_lshlrev_b32 v138, 16, v213
    v_and_b32 v139, 0xffff0000, v213
    v_lshlrev_b32 v140, 16, v214
    v_and_b32 v141, 0xffff0000, v214
    v_lshlrev_b32 v142, 16, v215
    v_and_b32 v143, 0xffff0000, v215
    v_lshlrev_b32 v144, 16, v216
    v_and_b32 v145, 0xffff0000, v216
    v_lshlrev_b32 v146, 16, v217
    v_and_b32 v147, 0xffff0000, v217
    v_lshlrev_b32 v148, 16, v218
    v_and_b32 v149, 0xffff0000, v218
    v_lshlrev_b32 v150, 16, v219
    v_and_b32 v151, 0xffff0000, v219
    v_pk_add_f32 v[24:25], v[128:129], v[130:131]
    v_pk_mul_f32 v[26:27], v[128:129], v[128:129]
    v_pk_fma_f32 v[26:27], v[130:131], v[130:131], v[26:27]
    v_pk_add_f32 v[24:25], v[24:25], v[132:133]
    v_pk_fma_f32 v[26:27], v[132:133], v[132:133], v[26:27]
    v_pk_add_f32 v[24:25], v[24:25], v[134:135]
    v_pk_fma_f32 v[26:27], v[134:135], v[134:135], v[26:27]
    v_pk_add_f32 v[24:25], v[24:25], v[136:137]
    v_pk_fma_f32 v[26:27], v[136:137], v[136:137], v[26:27]
    v_pk_add_f32 v[24:25], v[24:25], v[138:139]
    v_pk_fma_f32 v[26:27], v[138:139], v[138:139], v[26:27]
    v_pk_add_f32 v[24:25], v[24:25], v[140:141]
    v_pk_fma_f32 v[26:27], v[140:141], v[140:141], v[26:27]
    v_pk_add_f32 v[24:25], v[24:25], v[142:143]
    v_pk_fma_f32 v[26:27], v[142:143], v[142:143], v[26:27]
    v_pk_add_f32 v[24:25], v[24:25], v[144:145]
    v_pk_fma_f32 v[26:27], v[144:145], v[144:145], v[26:27]
    v_pk_add_f32 v[24:25], v[24:25], v[146:147]
    v_pk_fma_f32 v[26:27], v[146:147], v[146:147], v[26:27]
    v_pk_add_f32 v[24:25], v[24:25], v[148:149]
    v_pk_fma_f32 v[26:27], v[148:149], v[148:149], v[26:27]
    v_pk_add_f32 v[24:25], v[24:25], v[150:151]
    v_pk_fma_f32 v[26:27], v[150:151], v[150:151], v[26:27]
    v_add_f32 v24, v24, v25
    v_add_f32 v25, v26, v27
    s_nop 0
    v_add_f32_dpp v24, v24, v24 row_ror:8 row_mask:0xf bank_mask:0xf
    v_add_f32_dpp v25, v25, v25 row_ror:8 row_mask:0xf bank_mask:0xf
    s_nop 0
    v_add_f32_dpp v24, v24, v24 row_ror:4 row_mask:0xf bank_mask:0xf
    v_add_f32_dpp v25, v25, v25 row_ror:4 row_mask:0xf bank_mask:0xf
    s_nop 0
    v_add_f32_dpp v24, v24, v24 row_ror:2 row_mask:0xf bank_mask:0xf
    v_add_f32_dpp v25, v25, v25 row_ror:2 row_mask:0xf bank_mask:0xf
    s_nop 0
    v_add_f32_dpp v24, v24, v24 row_ror:1 row_mask:0xf bank_mask:0xf
    v_add_f32_dpp v25, v25, v25 row_ror:1 row_mask:0xf bank_mask:0xf
    v_mov_b32 v26, v24
    v_mov_b32 v27, v25
    s_nop 0
    v_permlane16_swap_b32 v24, v26
    v_permlane16_swap_b32 v25, v27
    v_add_f32 v24, v24, v26
    v_add_f32 v25, v25, v27
    v_mul_f32 v24, 0x3acccccd, v24
    v_mul_f32 v25, 0x3acccccd, v25
    v_fma_f32 v25, -v24, v24, v25
    v_max_f32 v25, 0, v25
    v_add_f32 v25, 0x3727c5ac, v25
    v_rsq_f32 v25, v25
    v_sub_f32 v24, 0, v24
    v_mul_f32 v24, v24, v25
    v_pk_fma_f32 v[128:129], v[128:129], v[24:25], v[24:25] op_sel:[0,1,0] op_sel_hi:[1,1,0]
    v_pk_fma_f32 v[130:131], v[130:131], v[24:25], v[24:25] op_sel:[0,1,0] op_sel_hi:[1,1,0]
    v_pk_fma_f32 v[132:133], v[132:133], v[24:25], v[24:25] op_sel:[0,1,0] op_sel_hi:[1,1,0]
    v_pk_fma_f32 v[134:135], v[134:135], v[24:25], v[24:25] op_sel:[0,1,0] op_sel_hi:[1,1,0]
    v_cvt_pk_bf16_f32 v208, v128, v129
    v_cvt_pk_bf16_f32 v209, v130, v131
    v_cvt_pk_bf16_f32 v210, v132, v133
    v_cvt_pk_bf16_f32 v211, v134, v135
    ds_write_b128 v88, v[208:211] offset:32768
    v_pk_fma_f32 v[136:137], v[136:137], v[24:25], v[24:25] op_sel:[0,1,0] op_sel_hi:[1,1,0]
    v_pk_fma_f32 v[138:139], v[138:139], v[24:25], v[24:25] op_sel:[0,1,0] op_sel_hi:[1,1,0]
    v_pk_fma_f32 v[140:141], v[140:141], v[24:25], v[24:25] op_sel:[0,1,0] op_sel_hi:[1,1,0]
    v_pk_fma_f32 v[142:143], v[142:143], v[24:25], v[24:25] op_sel:[0,1,0] op_sel_hi:[1,1,0]
    v_cvt_pk_bf16_f32 v212, v136, v137
    v_cvt_pk_bf16_f32 v213, v138, v139
    v_cvt_pk_bf16_f32 v214, v140, v141
    v_cvt_pk_bf16_f32 v215, v142, v143
    ds_write_b128 v88, v[212:215] offset:37376
    v_pk_fma_f32 v[144:145], v[144:145], v[24:25], v[24:25] op_sel:[0,1,0] op_sel_hi:[1,1,0]
    v_pk_fma_f32 v[146:147], v[146:147], v[24:25], v[24:25] op_sel:[0,1,0] op_sel_hi:[1,1,0]
    v_pk_fma_f32 v[148:149], v[148:149], v[24:25], v[24:25] op_sel:[0,1,0] op_sel_hi:[1,1,0]
    v_pk_fma_f32 v[150:151], v[150:151], v[24:25], v[24:25] op_sel:[0,1,0] op_sel_hi:[1,1,0]
    v_cvt_pk_bf16_f32 v216, v144, v145
    v_cvt_pk_bf16_f32 v217, v146, v147
    v_cvt_pk_bf16_f32 v218, v148, v149
    v_cvt_pk_bf16_f32 v219, v150, v151
    ds_write_b128 v88, v[216:219] offset:41984
    s_waitcnt lgkmcnt(0)
    s_mov_b32 s67, 0
L_place_3:
    s_cmp_lg_u32 s44, 0
    s_cbranch_scc1 L_placed_4
    v_mov_b32 v28, 0
    global_load_dword v28, v28, s[46:47] sc1
    s_waitcnt vmcnt(0)
    v_readfirstlane_b32 s44, v28
    s_add_u32 s67, s67, 1
    s_cmp_lt_u32 s67, 20000
    s_cbranch_scc1 L_place_3
L_placed_4:
    s_lshr_b32 s44, s44, 1
    s_lshr_b32 s76, s61, 3
    s_xor_b32 s44, s44, s76
    s_and_b32 s76, s61, 7
    s_lshl_b32 s45, s76, 21
    s_add_u32 s45, s45, 2097152
    s_bfe_u32 s77, s45, 65557
    s_xor_b32 s77, s77, s44
    s_lshl_b32 s77, s77, 13
    s_add_u32 s45, s45, s77
    s_lshl_b32 s46, s76, 1
    s_add_u32 s46, s46, s44
    s_lshl_b32 s46, s46, 13
    s_add_u32 s24, s24, s45
    s_waitcnt vmcnt(10)
    s_barrier
    ds_read_b128 v[208:211], v89 offset:32768
    ds_read_b128 v[212:215], v89 offset:37376
    ds_read_b128 v[216:219], v89 offset:41984
    ds_read_b64_tr_b16 v[128:129], v95 offset:20480
    ds_read_b64_tr_b16 v[136:137], v96 offset:20512
    ds_read_b64_tr_b16 v[130:131], v95 offset:21120
    ds_read_b64_tr_b16 v[138:139], v96 offset:21152
    ds_read_b64_tr_b16 v[132:133], v95 offset:25600
    ds_read_b64_tr_b16 v[140:141], v96 offset:25632
    ds_read_b64_tr_b16 v[134:135], v95 offset:26240
    ds_read_b64_tr_b16 v[142:143], v96 offset:26272
    s_waitcnt lgkmcnt(8)
    s_add_u32 s77, s24, 0
    buffer_store_dwordx4 v[208:211], v90, s[32:35], s77 offen sc1
    s_add_u32 s77, s24, 16384
    buffer_store_dwordx4 v[212:215], v90, s[32:35], s77 offen sc1
    s_add_u32 s77, s24, 32768
    buffer_store_dwordx4 v[216:219], v91, s[32:35], s77 offen sc1
    s_waitcnt vmcnt(8)
    buffer_load_dwordx4 v[152:155], v97, s[32:35], s25 offen sc1
    v_add_u32 v11, s46, v11
    s_lshl_b32 s65, s60, 11
    s_lshl_b32 s68, s62, 19
    s_add_u32 s68, s68, 18874368
    s_add_u32 s68, s68, s65
    s_lshl_b32 s69, s74, 18
    s_add_u32 s69, s69, 27262976
    s_add_u32 s69, s69, s65
    s_lshl_b32 s70, s62, 20
    s_add_u32 s70, s70, 37748736
    s_add_u32 s70, s70, s65
    s_lshl_b32 s71, s74, 20
    s_add_u32 s71, s71, 29360128
    s_add_u32 s71, s71, s65
    v_add_u32 v3, 0x10000, v2
    v_add_u32 v4, 0x20000, v2
    v_add_u32 v7, 49152, v2
    v_cmp_le_u32 vcc, 192, v0
    v_and_b32 v24, 0xffffff7f, v2
    s_nop 0
    v_cndmask_b32 v8, v2, v24, vcc
    v_cndmask_b32 v10, v2, v61, vcc
    s_mul_i32 s48, s60, 98304
    s_add_u32 s48, s48, s45
    s_cmp_eq_u32 s61, 8
    s_cselect_b32 s79, 1, 0
    s_xor_b32 s79, s79, s44
    s_add_u32 s80, s61, 7
    s_and_b32 s80, s80, 7
    s_lshl_b32 s49, s80, 21
    s_add_u32 s49, s49, 2441216
    s_bfe_u32 s76, s49, 65557
    s_xor_b32 s76, s76, s79
    s_lshl_b32 s76, s76, 13
    s_add_u32 s49, s49, s76
    s_lshl_b32 s80, s80, 1
    s_add_u32 s80, s80, s79
    s_lshl_b32 s80, s80, 13
    s_cmp_eq_u32 s61, 0
    s_cselect_b32 s49, 1073741824, s49
    s_cselect_b32 s80, s46, s80
    s_add_u32 s49, s49, s75
    v_min_u32 v23, 29, v1
    s_lshr_b32 s76, s62, 1
    v_lshl_add_u32 v23, v23, 3, s76
    v_lshlrev_b32 v23, 7, v23
    v_cmp_gt_u32 vcc, 16, v1
    v_lshl_add_u32 v243, v6, 7, s46
    v_or_b32 v24, 14, v6
    v_lshl_add_u32 v24, v24, 7, s80
    v_cndmask_b32 v243, v24, v243, vcc
    s_lshl_b32 s76, s60, 2
    s_lshr_b32 s50, 0x0610, s76
    s_and_b32 s50, s50, 15
    s_lshr_b32 s51, 0x4754, s76
    s_and_b32 s51, s51, 15
    v_lshl_add_u32 v244, s50, 10, v2
    v_lshl_add_u32 v248, s51, 10, v2
    v_lshl_add_u32 v245, s50, 10, v3
    v_lshl_add_u32 v249, s51, 10, v3
    v_lshl_add_u32 v246, s50, 10, v4
    v_lshl_add_u32 v250, s51, 10, v4
    v_and_b32 v24, 1, v63
    v_lshrrev_b32 v28, 1, v63
    v_lshl_add_u32 v28, v24, 1, v28
    s_lshl_b32 s76, s60, 5
    v_lshl_add_u32 v28, v28, 3, s76
    v_and_b32 v29, 1, v5
    v_lshrrev_b32 v30, 1, v5
    v_lshl_add_u32 v123, v29, 3, v62
    v_lshl_add_u32 v123, v30, 2, v123
    s_cmp_lt_u32 s90, 16
    s_cselect_b64 vcc, -1, 0
    s_mov_b32 s76, 512
    s_cselect_b32 s76, 2048, s76
    v_cndmask_b32 v123, v87, v123, vcc
    v_lshl_add_u32 v123, v123, 7, v28
    v_add_u32 v123, 70656, v123
    v_add_u32 v124, s76, v123
    s_cmp_lt_u32 s2, 216
    s_mov_b32 s79, 2560
    s_cselect_b32 s79, 512, s79
    s_mov_b32 s80, 5120
    s_cselect_b32 s80, 4096, s80
    v_lshl_add_u32 v192, v5, 2, v62
    v_cndmask_b32 v192, v192, v87, s[86:87]
    v_mul_u32_u24 v31, 80, v30
    v_lshl_add_u32 v31, v29, 3, v31
    v_add_u32 v31, 64, v31
    v_mad_u32_u24 v193, v5, 40, 16
    v_cndmask_b32 v193, v193, v31, s[86:87]
    v_add_u32 v193, v193, v62
    v_lshl_add_u32 v192, v192, 7, v28
    v_lshl_add_u32 v193, v193, 7, v28
    v_add_u32 v194, s80, v192
    v_add_u32 v195, s79, v192
    v_add_u32 v196, s79, v193
    v_add_u32 v197, s79, v194
    v_mov_b32 v125, 159744
    v_lshl_add_u32 v126, v31, 2, v125
    v_add_u32 v125, v101, v125
    v_lshlrev_b32 v127, 1, v31
    s_lshl_b32 s76, s91, 2
    s_add_u32 s76, s76, s60
    s_mul_i32 s77, s76, 13108
    s_lshr_b32 s77, s77, 16
    s_mul_i32 s78, s77, 5
    s_sub_u32 s78, s76, s78
    s_lshl_b32 s93, s77, 20
    s_add_u32 s93, s93, 29360128
    s_lshr_b32 s76, s78, 1
    s_lshl_b32 s81, s76, 11
    s_and_b32 s76, s78, 1
    s_lshl_b32 s76, s76, 7
    s_add_u32 s81, s81, s76
    s_cmp_eq_u32 s78, 4
    s_cselect_b32 s82, 0, 896
    v_lshrrev_b32 v24, 3, v6
    v_mul_lo_u32 v84, v24, s82
    s_mul_i32 s76, s90, 15360
    s_add_u32 s81, s81, s76
    v_add3_u32 v84, v84, v2, s81
    s_lshl_b32 s76, s89, 2
    s_add_u32 s76, s76, s60
    s_mul_i32 s77, s76, 13108
    s_lshr_b32 s77, s77, 16
    s_mul_i32 s78, s77, 5
    s_sub_u32 s78, s76, s78
    s_lshl_b32 s40, s77, 18
    s_add_u32 s40, s40, 27262976
    s_lshr_b32 s76, s78, 1
    s_lshl_b32 s81, s76, 11
    s_and_b32 s76, s78, 1
    s_lshl_b32 s76, s76, 7
    s_add_u32 s81, s81, s76
    s_cmp_eq_u32 s78, 4
    s_cselect_b32 s82, 0, 896
    v_mul_lo_u32 v198, v24, s82
    s_mov_b32 s42, 5120
    s_mov_b32 s43, 1073741824
    s_cmp_ge_u32 s2, 216
    s_cbranch_scc1 L_wo_5
    v_mov_b32 v198, 0
    s_lshl_b32 s76, s89, 2
    s_add_u32 s76, s76, s60
    s_sub_u32 s77, s76, 96
    s_cmp_ge_u32 s76, 102
    s_cselect_b32 s78, 2, 0
    s_add_u32 s77, s77, s78
    s_sub_u32 s79, s76, 64
    s_lshr_b32 s79, s79, 1
    s_and_b32 s80, s76, 1
    s_add_u32 s80, s80, 4
    s_cmp_lt_u32 s76, 96
    s_cselect_b32 s77, s79, s77
    s_cselect_b32 s78, s80, 6
    s_cmp_lt_u32 s76, 64
    s_cselect_b32 s77, s89, s77
    s_cselect_b32 s78, s60, s78
    s_cselect_b32 s42, 8, 6
    s_cselect_b32 s79, 0, 155648
    s_lshl_b32 s42, s42, 10
    s_lshl_b32 s78, s78, 1
    s_add_u32 s78, s78, s92
    s_lshl_b32 s40, s77, 20
    s_lshl_b32 s81, s78, 10
    s_add_u32 s81, s81, s79
    s_add_u32 s40, s40, 37748736
    s_lshl_b32 s43, s77, 2
    s_add_u32 s43, s43, s88
    s_mul_i32 s43, s43, 1792
    s_lshl_b32 s79, s78, 6
    s_add_u32 s43, s43, s79
    s_add_u32 s43, s43, 1441792
L_wo_5:
    v_add3_u32 v198, v198, v2, s81
    s_waitcnt vmcnt(0)
    s_mov_b32 s67, 0
L_gat_6:
    v_min3_u32 v24, v153, v155, s64
    v_max3_u32 v25, v153, v155, s64
    v_cmp_ne_u32 vcc, v24, v25
    s_nop 0
    s_cbranch_vccz L_gdone_7
    buffer_load_dwordx4 v[152:155], v97, s[32:35], s25 offen sc1
    s_waitcnt vmcnt(0)
    s_add_u32 s67, s67, 1
    s_cmp_lt_u32 s67, 20000
    s_cbranch_scc1 L_gat_6
L_gdone_7:
    buffer_load_dwordx4 v[224:227], v120, s[32:35], 0 offen offset:0 sc1
    buffer_load_dwordx4 v[228:231], v120, s[32:35], 0 offen offset:512 sc1
    buffer_load_dwordx4 v[232:235], v120, s[32:35], 0 offen offset:1024 sc1
    buffer_load_dwordx4 v[236:239], v120, s[32:35], 0 offen offset:1536 sc1
    v_mov_b32 v153, v152
    v_mov_b32 v155, v154
    s_nop 0
    v_permlane16_swap_b32 v152, v153
    v_permlane16_swap_b32 v154, v155
    v_add_f32 v152, v152, v153
    v_add_f32 v154, v154, v155
    v_mov_b32 v153, v152
    v_mov_b32 v155, v154
    s_nop 0
    v_permlane32_swap_b32 v152, v153
    v_permlane32_swap_b32 v154, v155
    v_add_f32 v152, v152, v153
    v_add_f32 v154, v154, v155
    v_cvt_pk_bf16_f32 v24, v152, v154
    ds_write_b32 v98, v24 offset:47616
    v_lshlrev_b32 v26, 16, v24
    v_and_b32 v27, 0xffff0000, v24
    v_add_f32 v26, 1.0, v26
    v_add_f32 v27, 1.0, v27
    v_cvt_pk_bf16_f32 v27, v26, v27
    v_lshlrev_b32 v26, 16, v27
    v_and_b32 v27, 0xffff0000, v27
    ds_write_b64 v99, v[26:27] offset:48128
    s_waitcnt lgkmcnt(0)
    s_barrier
    ds_read_b128 v[152:155], v101 offset:48384
    ds_read_b128 v[156:159], v101 offset:48400
    ds_read_b128 v[160:163], v101 offset:48512
    ds_read_b128 v[164:167], v101 offset:48528
    ds_read_b128 v[144:147], v100 offset:47616
    ds_read_b128 v[148:151], v100 offset:47680
    s_mov_b32 s67, 196608
    buffer_store_dword v22, v11, s[32:35], s67 offen sc1
    s_waitcnt lgkmcnt(4)
    v_lshlrev_b32 v32, 16, v128
    v_and_b32 v33, 0xffff0000, v128
    v_lshlrev_b32 v34, 16, v129
    v_and_b32 v35, 0xffff0000, v129
    v_lshlrev_b32 v36, 16, v130
    v_and_b32 v37, 0xffff0000, v130
    v_lshlrev_b32 v38, 16, v131
L_pad0:
    s_cbranch_execz L_pad4
    v_and_b32 v39, 0xffff0000, v131
    v_pk_mul_f32 v[32:33], v[32:33], v[152:153]
    v_pk_mul_f32 v[34:35], v[34:35], v[154:155]
    v_pk_mul_f32 v[36:37], v[36:37], v[156:157]
    v_pk_mul_f32 v[38:39], v[38:39], v[158:159]
    v_cvt_pk_bf16_f32 v104, v32, v33
    v_cvt_pk_bf16_f32 v105, v34, v35
    v_cvt_pk_bf16_f32 v106, v36, v37
    v_cvt_pk_bf16_f32 v107, v38, v39
    buffer_store_dwordx4 v[104:107], v2, s[8:11], s16 offen sc1
    s_add_u32 s16, s16, 8192
    s_waitcnt lgkmcnt(0)
    v_mfma_f32_16x16x32_bf16 v[168:171], v[128:131], v[144:147], 0
    v_mfma_f32_16x16x32_bf16 v[172:175], v[136:139], v[144:147], 0
    v_mfma_f32_16x16x32_bf16 v[168:171], v[132:135], v[148:151], v[168:171]
    v_mfma_f32_16x16x32_bf16 v[172:175], v[140:143], v[148:151], v[172:175]
    v_lshlrev_b32 v32, 16, v132
    v_and_b32 v33, 0xffff0000, v132
    v_lshlrev_b32 v34, 16, v133
    v_and_b32 v35, 0xffff0000, v133
    v_lshlrev_b32 v36, 16, v134
    v_and_b32 v37, 0xffff0000, v134
    v_lshlrev_b32 v38, 16, v135
    v_and_b32 v39, 0xffff0000, v135
    v_pk_mul_f32 v[32:33], v[32:33], v[160:161]
    v_pk_mul_f32 v[34:35], v[34:35], v[162:163]
    v_pk_mul_f32 v[36:37], v[36:37], v[164:165]
    v_pk_mul_f32 v[38:39], v[38:39], v[166:167]
    v_cvt_pk_bf16_f32 v108, v32, v33
    v_cvt_pk_bf16_f32 v109, v34, v35
    v_cvt_pk_bf16_f32 v110, v36, v37
    v_cvt_pk_bf16_f32 v111, v38, v39
    buffer_store_dwordx4 v[108:111], v2, s[8:11], s16 offen sc1
    s_add_u32 s16, s16, 8192
    s_cmp_lg_u32 s60, 1
    s_cbranch_scc1 L_notleft_9
    v_lshlrev_b32 v32, 16, v136
    v_and_b32 v33, 0xffff0000, v136
    v_lshlrev_b32 v34, 16, v137
    v_and_b32 v35, 0xffff0000, v137
    v_lshlrev_b32 v36, 16, v138
    v_and_b32 v37, 0xffff0000, v138
    v_lshlrev_b32 v38, 16, v139
    v_and_b32 v39, 0xffff0000, v139
    v_pk_mul_f32 v[32:33], v[32:33], v[152:153]
    v_pk_mul_f32 v[34:35], v[34:35], v[154:155]
    v_pk_mul_f32 v[36:37], v[36:37], v[156:157]
    v_pk_mul_f32 v[38:39], v[38:39], v[158:159]
    v_cvt_pk_bf16_f32 v112, v32, v33
    v_cvt_pk_bf16_f32 v113, v34, v35
    v_cvt_pk_bf16_f32 v114, v36, v37
    v_cvt_pk_bf16_f32 v115, v38, v39
    s_add_u32 s76, s17, 0
    buffer_store_dwordx4 v[112:115], v102, s[8:11], s76 offen sc1
    s_branch L_left_8
L_notleft_9:
    s_cmp_lg_u32 s60, 2
    s_cbranch_scc1 L_notleft_10
    v_lshlrev_b32 v32, 16, v140
    v_and_b32 v33, 0xffff0000, v140
    v_lshlrev_b32 v34, 16, v141
    v_and_b32 v35, 0xffff0000, v141
    v_lshlrev_b32 v36, 16, v142
    v_and_b32 v37, 0xffff0000, v142
    v_lshlrev_b32 v38, 16, v143
    v_and_b32 v39, 0xffff0000, v143
    v_pk_mul_f32 v[32:33], v[32:33], v[160:161]
    v_pk_mul_f32 v[34:35], v[34:35], v[162:163]
    v_pk_mul_f32 v[36:37], v[36:37], v[164:165]
    v_pk_mul_f32 v[38:39], v[38:39], v[166:167]
    v_cvt_pk_bf16_f32 v112, v32, v33
    v_cvt_pk_bf16_f32 v113, v34, v35
    v_cvt_pk_bf16_f32 v114, v36, v37
    v_cvt_pk_bf16_f32 v115, v38, v39
    s_add_u32 s76, s17, 8192
    buffer_store_dwordx4 v[112:115], v102, s[8:11], s76 offen sc1
    s_branch L_left_8
L_notleft_10:
    s_cmp_lg_u32 s60, 0
    s_cbranch_scc1 L_left_8
    buffer_store_dwordx4 v[172:175], v85, s[8:11], s18 offen offset:256 sc1
L_left_8:
    buffer_store_dwordx4 v[168:171], v85, s[8:11], s18 offen sc1
    ds_read_b64_tr_b16 v[140:141], v192 offset:50176
    ds_read_b64_tr_b16 v[142:143], v195 offset:50176
    ds_read_b64_tr_b16 v[144:145], v194 offset:50176
    ds_read_b64_tr_b16 v[146:147], v197 offset:50176
    ds_read_b64_tr_b16 v[148:149], v192 offset:60416
    ds_read_b64_tr_b16 v[150:151], v195 offset:60416
    ds_read_b64_tr_b16 v[152:153], v194 offset:60416
    ds_read_b64_tr_b16 v[154:155], v197 offset:60416
    ds_read_b64_tr_b16 v[156:157], v193 offset:50176
    ds_read_b64_tr_b16 v[158:159], v196 offset:50176
    s_waitcnt vmcnt(4)
    s_mov_b32 s67, 0
L_gat_11:
    v_min3_u32 v24, v225, v227, s64
    v_max3_u32 v25, v225, v227, s64
    v_min3_u32 v24, v24, v229, v231
    v_max3_u32 v25, v25, v229, v231
    v_min3_u32 v24, v24, v233, v235
    v_max3_u32 v25, v25, v233, v235
    v_min3_u32 v24, v24, v237, v239
    v_max3_u32 v25, v25, v237, v239
    v_cmp_ne_u32 vcc, v24, v25
    s_nop 0
    s_cbranch_vccz L_gdone_12
    buffer_load_dwordx4 v[224:227], v120, s[32:35], 0 offen offset:0 sc1
    buffer_load_dwordx4 v[228:231], v120, s[32:35], 0 offen offset:512 sc1
    buffer_load_dwordx4 v[232:235], v120, s[32:35], 0 offen offset:1024 sc1
    buffer_load_dwordx4 v[236:239], v120, s[32:35], 0 offen offset:1536 sc1
    s_waitcnt vmcnt(0)
    s_add_u32 s67, s67, 1
    s_cmp_lt_u32 s67, 20000
    s_cbranch_scc1 L_gat_11
L_gdone_12:
    v_add_f32 v224, v224, v228
    v_add_f32 v226, v226, v230
    v_add_f32 v224, v224, v232
    v_add_f32 v226, v226, v234
    v_add_f32 v224, v224, v236
    v_add_f32 v226, v226, v238
    v_cvt_pk_bf16_f32 v24, v224, v226
    v_lshlrev_b32 v25, 2, v0
    ds_write_b32 v25, v24 offset:49152
    v_lshlrev_b32 v28, 16, v24
    v_and_b32 v29, 0xffff0000, v24
    v_add_f32 v28, 1.0, v28
    v_add_f32 v29, 1.0, v29
    v_cvt_pk_bf16_f32 v29, v28, v29
    v_lshlrev_b32 v28, 16, v29
    v_and_b32 v29, 0xffff0000, v29
    v_cmp_gt_u32 vcc, 80, v0
    v_lshlrev_b32 v26, 16, v24
    v_and_b32 v27, 0xffff0000, v24
    v_cndmask_b32 v28, 1.0, v28, s[86:87]
    v_cndmask_b32 v26, v26, v28, vcc
    v_cndmask_b32 v29, 1.0, v29, s[86:87]
    v_cndmask_b32 v27, v27, v29, vcc
    v_mov_b32 v25, 159744
    v_lshl_add_u32 v25, v0, 3, v25
    ds_write_b64 v25, v[26:27]
    v_mov_b32 v184, 0x3f803f80
    v_mov_b32 v185, 0x3f803f80
    v_mov_b32 v186, 0x3f803f80
    v_mov_b32 v187, 0x3f803f80
    s_waitcnt vmcnt(0)
    s_waitcnt lgkmcnt(0)
    s_mov_b32 s3, 196608
    buffer_load_dword v242, v243, s[32:35], s3 offen sc1
    s_barrier
    s_mov_b32 s67, 327680
    buffer_store_dword v22, v94, s[32:35], s67 offen sc1
    ds_read_b128 v[200:203], v125 offset:0
    ds_read_b128 v[204:207], v125 offset:16
    ds_read_b128 v[160:163], v100 offset:49664
    ds_read_b128 v[208:211], v125 offset:128
    ds_read_b128 v[212:215], v125 offset:144
    ds_read_b128 v[164:167], v100 offset:49728
    ds_read_b128 v[216:219], v125 offset:320
    ds_read_b128 v[220:223], v125 offset:336
    ds_read_b128 v[168:171], v100 offset:49824
    ds_read_b128 v[224:227], v125 offset:448
    ds_read_b128 v[228:231], v125 offset:464
    ds_read_b128 v[172:175], v100 offset:49888
    ds_read_b128 v[232:235], v126 offset:0
    ds_read_b128 v[236:239], v126 offset:16
    ds_read_b128 v[176:179], v127 offset:49664
    s_mul_i32 s76, s88, s42
    s_lshl_b32 s77, s42, 4
    s_add_u32 s77, s77, s76
    s_lshl_b32 s76, s76, 2
    v_add_u32 v114, s77, v198
    v_add_u32 v110, s76, v198
    v_add_u32 v111, s42, v110
    v_add_u32 v112, s42, v111
    v_add_u32 v113, s42, v112
    v_add_u32 v28, 0, v84
    v_add_u32 v29, 5120, v84
    v_add_u32 v84, 10240, v84
    s_add_u32 s41, s40, 8192
    s_add_u32 s42, s93, 8192
    s_cmp_lt_u32 s2, 216
    s_cbranch_scc1 L_notwo_13
    buffer_store_dwordx4 v[140:143], v110, s[32:35], s40 offen sc1
    buffer_store_dwordx4 v[144:147], v111, s[32:35], s40 offen sc1
    buffer_store_dwordx4 v[148:151], v112, s[32:35], s40 offen sc1
    buffer_store_dwordx4 v[152:155], v113, s[32:35], s40 offen sc1
    buffer_store_dwordx4 v[156:159], v114, s[32:35], s40 offen sc1
    s_mov_b32 s40, 1073741824
    s_mov_b32 s41, 1073741824
L_notwo_13:
    s_waitcnt vmcnt(1)
    v_subrev_u32 v242, s64, v242
    v_cmp_lt_u32 vcc, 7, v242
    s_nop 0
    s_cbranch_vccz L_probed_14
    s_mov_b32 s67, 0
L_poll_15:
    s_mov_b32 s76, 196608
    buffer_load_dword v242, v243, s[32:35], s76 offen sc1
    s_waitcnt vmcnt(0)
    v_subrev_u32 v242, s64, v242
    v_cmp_lt_u32 vcc, 7, v242
    s_nop 0
    s_cbranch_vccz L_ready_16
    s_add_u32 s67, s67, 1
    s_cmp_lt_u32 s67, 20000
    s_cbranch_scc1 L_poll_15
L_ready_16:
L_probed_14:
    s_add_u32 m0, s75, 139264
    s_add_u32 s66, s49, 0
    buffer_load_dwordx4 v2, s[32:35], s66 offen sc1 lds
    s_add_u32 s78, s48, 0
    buffer_load_dwordx4 a[0:3], v2, s[32:35], s78 offen offset:0 sc1
    buffer_load_dwordx4 a[4:7], v7, s[32:35], s78 offen offset:0 sc1
    buffer_load_dwordx4 a[8:11], v2, s[32:35], s78 offen offset:1024 sc1
    buffer_load_dwordx4 a[12:15], v7, s[32:35], s78 offen offset:1024 sc1
    buffer_load_dwordx4 a[16:19], v2, s[32:35], s78 offen offset:2048 sc1
    buffer_load_dwordx4 a[20:23], v7, s[32:35], s78 offen offset:2048 sc1
    buffer_load_dwordx4 a[24:27], v2, s[32:35], s78 offen offset:3072 sc1
    s_waitcnt lgkmcnt(0)
    ds_read_b64_tr_b16 v[72:73], v123 offset:0
    ds_read_b64_tr_b16 v[74:75], v124 offset:0
    ds_read_b64_tr_b16 v[76:77], v123 offset:4096
    ds_read_b64_tr_b16 v[78:79], v124 offset:4096
    ds_read_b64_tr_b16 v[80:81], v123 offset:8192
    ds_read_b64_tr_b16 v[82:83], v124 offset:8192
    v_mfma_f32_16x16x32_bf16 v[68:71], v[140:143], v[160:163], 0
    v_lshlrev_b32 v32, 16, v140
    v_and_b32 v33, 0xffff0000, v140
    v_lshlrev_b32 v34, 16, v141
    v_and_b32 v35, 0xffff0000, v141
    v_lshlrev_b32 v36, 16, v142
    v_and_b32 v37, 0xffff0000, v142
    v_lshlrev_b32 v38, 16, v143
    v_and_b32 v39, 0xffff0000, v143
    v_pk_mul_f32 v[32:33], v[32:33], v[200:201]
    v_pk_mul_f32 v[34:35], v[34:35], v[202:203]
    v_pk_mul_f32 v[36:37], v[36:37], v[204:205]
    v_pk_mul_f32 v[38:39], v[38:39], v[206:207]
    v_cvt_pk_bf16_f32 v40, v32, v33
    v_cvt_pk_bf16_f32 v41, v34, v35
    v_cvt_pk_bf16_f32 v42, v36, v37
    v_cvt_pk_bf16_f32 v43, v38, v39
    buffer_load_dwordx4 a[28:31], v7, s[32:35], s78 offen offset:3072 sc1
    v_mfma_f32_16x16x32_bf16 v[68:71], v[144:147], v[164:167], v[68:71]
    v_mfma_f32_16x16x32_bf16 v[64:67], v[40:43], v[184:187], 0
    v_lshlrev_b32 v32, 16, v144
    v_and_b32 v33, 0xffff0000, v144
    v_lshlrev_b32 v34, 16, v145
    v_and_b32 v35, 0xffff0000, v145
    v_lshlrev_b32 v36, 16, v146
    v_and_b32 v37, 0xffff0000, v146
    v_lshlrev_b32 v38, 16, v147
    v_and_b32 v39, 0xffff0000, v147
    v_pk_mul_f32 v[32:33], v[32:33], v[208:209]
    v_pk_mul_f32 v[34:35], v[34:35], v[210:211]
    v_pk_mul_f32 v[36:37], v[36:37], v[212:213]
    v_pk_mul_f32 v[38:39], v[38:39], v[214:215]
    v_cvt_pk_bf16_f32 v44, v32, v33
    v_cvt_pk_bf16_f32 v45, v34, v35
    v_cvt_pk_bf16_f32 v46, v36, v37
    v_cvt_pk_bf16_f32 v47, v38, v39
    s_add_u32 m0, s75, 143360
    s_add_u32 s66, s49, 4096
    buffer_load_dwordx4 v2, s[32:35], s66 offen sc1 lds
    v_mfma_f32_16x16x32_bf16 v[68:71], v[148:151], v[168:171], v[68:71]
    v_mfma_f32_16x16x32_bf16 v[64:67], v[44:47], v[184:187], v[64:67]
    v_lshlrev_b32 v32, 16, v148
    v_and_b32 v33, 0xffff0000, v148
    v_lshlrev_b32 v34, 16, v149
    v_and_b32 v35, 0xffff0000, v149
    v_lshlrev_b32 v36, 16, v150
    v_and_b32 v37, 0xffff0000, v150
    v_lshlrev_b32 v38, 16, v151
    v_and_b32 v39, 0xffff0000, v151
    v_pk_mul_f32 v[32:33], v[32:33], v[216:217]
    v_pk_mul_f32 v[34:35], v[34:35], v[218:219]
    v_pk_mul_f32 v[36:37], v[36:37], v[220:221]
    v_pk_mul_f32 v[38:39], v[38:39], v[222:223]
    v_cvt_pk_bf16_f32 v48, v32, v33
    v_cvt_pk_bf16_f32 v49, v34, v35
    v_cvt_pk_bf16_f32 v50, v36, v37
    v_cvt_pk_bf16_f32 v51, v38, v39
    s_add_u32 s78, s48, 4096
    buffer_load_dwordx4 a[32:35], v2, s[32:35], s78 offen offset:0 sc1
    v_mfma_f32_16x16x32_bf16 v[68:71], v[152:155], v[172:175], v[68:71]
    v_mfma_f32_16x16x32_bf16 v[64:67], v[48:51], v[184:187], v[64:67]
    v_lshlrev_b32 v32, 16, v152
    v_and_b32 v33, 0xffff0000, v152
    v_lshlrev_b32 v34, 16, v153
    v_and_b32 v35, 0xffff0000, v153
    v_lshlrev_b32 v36, 16, v154
    v_and_b32 v37, 0xffff0000, v154
    v_lshlrev_b32 v38, 16, v155
    v_and_b32 v39, 0xffff0000, v155
    v_pk_mul_f32 v[32:33], v[32:33], v[224:225]
    v_pk_mul_f32 v[34:35], v[34:35], v[226:227]
    v_pk_mul_f32 v[36:37], v[36:37], v[228:229]
    v_pk_mul_f32 v[38:39], v[38:39], v[230:231]
    v_cvt_pk_bf16_f32 v52, v32, v33
    v_cvt_pk_bf16_f32 v53, v34, v35
    v_cvt_pk_bf16_f32 v54, v36, v37
    v_cvt_pk_bf16_f32 v55, v38, v39
    buffer_load_dwordx4 a[36:39], v7, s[32:35], s78 offen offset:0 sc1
    v_mfma_f32_16x16x32_bf16 v[68:71], v[156:159], v[176:179], v[68:71]
    v_mfma_f32_16x16x32_bf16 v[64:67], v[52:55], v[184:187], v[64:67]
    v_lshlrev_b32 v32, 16, v156
    v_and_b32 v33, 0xffff0000, v156
    v_lshlrev_b32 v34, 16, v157
    v_and_b32 v35, 0xffff0000, v157
    v_lshlrev_b32 v36, 16, v158
    v_and_b32 v37, 0xffff0000, v158
    v_lshlrev_b32 v38, 16, v159
    v_and_b32 v39, 0xffff0000, v159
    v_pk_mul_f32 v[32:33], v[32:33], v[232:233]
    v_pk_mul_f32 v[34:35], v[34:35], v[234:235]
    v_pk_mul_f32 v[36:37], v[36:37], v[236:237]
    v_pk_mul_f32 v[38:39], v[38:39], v[238:239]
    v_cvt_pk_bf16_f32 v56, v32, v33
    v_cvt_pk_bf16_f32 v57, v34, v35
    v_cvt_pk_bf16_f32 v58, v36, v37
    v_cvt_pk_bf16_f32 v59, v38, v39
    buffer_load_dwordx4 a[40:43], v2, s[32:35], s78 offen offset:1024 sc1
    s_nop 0
    v_mfma_f32_16x16x32_bf16 v[64:67], v[56:59], v[184:187], v[64:67]
    s_waitcnt lgkmcnt(0)
    buffer_load_dwordx4 a[44:47], v7, s[32:35], s78 offen offset:1024 sc1
    v_and_b32 v24, 31, v1
    s_lshl_b32 s76, s60, 7
    s_add_u32 s76, s76, 161792
    v_lshl_add_u32 v38, v24, 2, s76
    s_and_b32 s76, s62, 1
    s_lshl_b32 s77, s76, 7
    v_lshl_add_u32 v37, v24, 2, s77
    s_lshl_b32 s77, s76, 5
    s_add_u32 s77, s77, 256
    buffer_load_dwordx4 a[48:51], v2, s[32:35], s78 offen offset:2048 sc1
    v_and_b32 v25, 7, v1
    v_lshl_add_u32 v25, v25, 2, s77
    v_lshrrev_b32 v24, 3, v24
    v_min_u32 v24, 2, v24
    v_cmp_le_u32 vcc, 192, v0
    v_mov_b32 v26, s60
    v_lshrrev_b32 v27, 5, v1
    v_cndmask_b32 v37, v37, v25, vcc
    v_cndmask_b32 v24, v26, v24, vcc
    buffer_load_dwordx4 a[52:55], v7, s[32:35], s78 offen offset:2048 sc1
    v_lshlrev_b32 v24, 2, v24
    v_mov_b32 v26, 0x201
    v_bfe_u32 v24, v26, v24, 4
    v_mul_u32_u24 v24, 25600, v24
    v_mul_u32_u24 v27, 1600, v27
    v_add3_u32 v37, v37, v24, v27
    s_lshr_b32 s83, s62, 1
    s_mul_i32 s83, s83, 3200
    s_add_u32 s83, s83, 1310720
    buffer_load_dwordx4 a[56:59], v2, s[32:35], s78 offen offset:3072 sc1
    v_mov_b32 v24, 161792
    v_lshl_add_u32 v30, v5, 4, v24
    v_lshl_add_u32 v31, v6, 2, v24
    v_lshl_add_u32 v247, s50, 6, v30
    v_lshl_add_u32 v251, s51, 6, v31
    s_mul_i32 s76, s60, 3072
    s_add_u32 s76, s76, 139264
    v_lshl_add_u32 v96, v1, 3, s76
    buffer_load_dwordx4 a[60:63], v7, s[32:35], s78 offen offset:3072 sc1
    s_lshl_b32 s76, s60, 9
    s_cmp_eq_u32 s60, 3
    s_cselect_b32 s76, 15360, s76
    s_add_u32 s76, s76, 139264
    v_lshl_add_u32 v97, v1, 3, s76
    v_cmp_eq_u32 vcc, 1, v5
    v_and_b32 v100, 1, v6
    v_lshl_add_u32 v101, v5, 2, v100
    v_cndmask_b32 v99, 0, -1, vcc
    v_cmp_eq_u32 vcc, 0, v5
    s_add_u32 m0, s75, 147456
    s_add_u32 s66, s49, 16384
    buffer_load_dwordx4 v2, s[32:35], s66 offen sc1 lds
    v_cmp_eq_u32 s[16:17], 1, v100
    v_cmp_le_u32 s[18:19], v101, v6
    v_cndmask_b32 v98, 0, -1, vcc
    v_cndmask_b32 v102, v61, v2, vcc
    v_add_u32 v101, 2, v101
    v_cmp_le_u32 s[20:21], v101, v6
    v_cmp_le_u32 vcc, 128, v0
    s_nop 1
    v_cndmask_b32 v9, v2, v61, vcc
    s_add_u32 s78, s48, 16384
    buffer_load_dwordx4 a[64:67], v2, s[32:35], s78 offen offset:0 sc1
    s_add_u32 s76, s60, 0
    s_lshr_b32 s76, 0x24, s76
    s_and_b32 s76, s76, 1
    s_mul_i32 s76, s76, s74
    s_cmp_ge_u32 s76, 6
    s_cselect_b32 s76, 1073741824, 0
    v_add_u32 v240, s76, v2
    s_add_u32 s76, s60, 1
    s_lshr_b32 s76, 0x24, s76
    s_and_b32 s76, s76, 1
    buffer_load_dwordx4 a[68:71], v7, s[32:35], s78 offen offset:0 sc1
    s_mul_i32 s76, s76, s74
    s_cmp_ge_u32 s76, 6
    s_cselect_b32 s76, 1073741824, 0
    v_add_u32 v241, s76, v2
    s_add_u32 s76, s60, 2
    s_lshr_b32 s76, 0x24, s76
    s_and_b32 s76, s76, 1
    s_mul_i32 s76, s76, s74
    s_cmp_ge_u32 s76, 6
    s_cselect_b32 s76, 1073741824, 0
    v_add_u32 v242, s76, v2
    buffer_load_dwordx4 a[72:75], v2, s[32:35], s78 offen offset:1024 sc1
    v_lshrrev_b32 v24, 2, v1
    v_mul_u32_u24 v253, 1280, v24
    v_lshl_add_u32 v252, v63, 4, v253
    v_and_b32 v24, 1, v63
    v_lshl_add_u32 v253, v24, 4, v253
    v_lshrrev_b32 v24, 1, v63
    v_lshl_add_u32 v253, v24, 3, v253
    s_mul_i32 s94, s73, 20480
    s_mul_i32 s77, s74, 160
    buffer_load_dwordx4 a[76:79], v7, s[32:35], s78 offen offset:1024 sc1
    s_add_u32 s94, s94, s77
    v_and_b32 v24, 3, v1
    v_bfe_u32 v25, v1, 2, 1
    v_mul_u32_u24 v25, 108, v25
    v_add_u32 v24, v24, v25
    s_lshr_b32 s76, s62, 1
    s_add_u32 s76, s76, 16
    v_mov_b32 v26, s76
    s_lshr_b32 s77, s62, 3
    buffer_load_dwordx4 a[80:83], v2, s[32:35], s78 offen offset:2048 sc1
    s_mul_i32 s77, s77, 6
    s_min_u32 s76, s74, 5
    s_add_u32 s77, s77, s76
    s_lshr_b32 s77, s77, 2
    v_cmp_gt_u32 vcc, 16, v1
    s_add_u32 s77, s77, 24
    v_mov_b32 v25, s77
    v_cndmask_b32 v25, v25, v26, vcc
    v_cmp_gt_u32 vcc, 8, v1
    buffer_load_dwordx4 a[84:87], v7, s[32:35], s78 offen offset:2048 sc1
    v_mov_b32 v26, s62
    s_mul_i32 s76, s74, 5
    v_cndmask_b32 v25, v25, v26, vcc
    v_lshl_add_u32 v24, v25, 2, v24
    s_and_b32 s77, s76, 0xfc
    s_add_u32 s77, s77, 216
    v_and_b32 v25, 7, v1
    v_add_u32 v25, s77, v25
    v_lshlrev_b32 v239, 7, v25
    buffer_load_dwordx4 a[88:91], v2, s[32:35], s78 offen offset:3072 sc1
    s_lshr_b32 s76, s76, 2
    s_mul_i32 s76, s76, 18
    s_add_u32 s76, s76, 52
    v_cmp_gt_u32 vcc, 24, v1
    v_min_u32 v25, 59, v1
    v_add_u32 v25, s76, v25
    s_mov_b32 s3, 327680
    buffer_load_dword v39, v23, s[32:35], s3 offen sc1
    v_cndmask_b32 v11, v25, v24, vcc
    v_lshlrev_b32 v11, 7, v11
    s_and_b32 s76, s62, 8
    s_add_u32 s76, s76, s62
    s_lshl_b32 s76, s76, 10
    s_add_u32 s76, s76, s48
    s_add_u32 s22, s76, 393216
    s_add_u32 s23, s76, 442368
    s_lshl_b32 s76, s62, 8
    s_add_u32 s76, s76, s48
    s_add_u32 s24, s76, 425984
    s_add_u32 s25, s76, 475136
    s_mov_b32 s84, 0x3ea52b5c
    v_mov_b32 v26, 0x3f803f80
    v_mov_b32 v24, 0xff800000
    v_mov_b32 v25, 0x0c0c0c0c
    s_cmp_eq_u32 s72, 0
    s_cselect_b32 s76, 0xff800000, 0
    v_cndmask_b32 v100, v24, 0, s[16:17]
    v_cndmask_b32 v101, 0, v24, s[16:17]
    v_cndmask_b32 v86, v24, v101, s[18:19]
    v_cndmask_b32 v90, v101, v24, s[18:19]
    v_accvgpr_write_b32 a160, v26
    v_add_f32 v124, s76, v90
    v_mov_b32 v108, 0
    v_cndmask_b32 v87, v24, v100, s[18:19]
    v_cndmask_b32 v91, v100, v24, s[18:19]
    v_accvgpr_write_b32 a161, v26
    v_add_f32 v125, s76, v91
    v_mov_b32 v109, 0
    v_cndmask_b32 v88, v24, v101, s[20:21]
    v_cndmask_b32 v92, v101, v24, s[20:21]
    v_accvgpr_write_b32 a162, v26
    v_add_f32 v126, s76, v92
    v_mov_b32 v116, 0
    v_cndmask_b32 v89, v24, v100, s[20:21]
    v_cndmask_b32 v93, v100, v24, s[20:21]
    v_accvgpr_write_b32 a163, v26
    v_add_f32 v127, s76, v93
    v_mov_b32 v117, 0
    v_mov_b32 v26, 202113280
    v_mov_b32 v27, 16780300
    v_cndmask_b32 v26, v26, v27, s[16:17]
    v_cndmask_b32 v94, v26, v25, s[18:19]
    v_cndmask_b32 v237, v25, v26, s[18:19]
    v_mov_b32 v26, 202113794
    v_mov_b32 v27, 50465804
    v_cndmask_b32 v26, v26, v27, s[16:17]
    v_cndmask_b32 v95, v26, v25, s[20:21]
    v_cndmask_b32 v238, v25, v26, s[20:21]
    s_waitcnt vmcnt(0)
    v_subrev_u32 v39, s64, v39
    v_cmp_lt_u32 vcc, 7, v39
    s_nop 0
    s_cbranch_vccz L_probed_17
    s_mov_b32 s67, 0
L_poll_18:
    s_mov_b32 s76, 327680
    buffer_load_dword v39, v23, s[32:35], s76 offen sc1
    s_waitcnt vmcnt(0)
    v_subrev_u32 v39, s64, v39
    v_cmp_lt_u32 vcc, 7, v39
    s_nop 0
    s_cbranch_vccz L_ready_19
    s_add_u32 s67, s67, 1
    s_cmp_lt_u32 s67, 20000
    s_cbranch_scc1 L_poll_18
L_ready_19:
L_probed_17:
    s_add_u32 m0, s65, 90112
    s_add_u32 s47, s68, 0
    buffer_load_dwordx4 v2, s[32:35], s47 offen sc1 lds
    buffer_load_dwordx4 v8, s[32:35], s47 offen offset:1024 sc1 lds
    s_add_u32 m0, s65, 98304
    s_add_u32 s47, s68, 8192
    buffer_load_dwordx4 v2, s[32:35], s47 offen sc1 lds
    buffer_load_dwordx4 v8, s[32:35], s47 offen offset:1024 sc1 lds
    s_add_u32 m0, s65, 106496
    s_add_u32 s47, s68, 16384
    buffer_load_dwordx4 v2, s[32:35], s47 offen sc1 lds
    buffer_load_dwordx4 v8, s[32:35], s47 offen offset:1024 sc1 lds
    s_add_u32 m0, s65, 114688
    s_add_u32 s47, s68, 24576
    buffer_load_dwordx4 v2, s[32:35], s47 offen sc1 lds
    buffer_load_dwordx4 v8, s[32:35], s47 offen offset:1024 sc1 lds
    s_waitcnt vmcnt(6)
    s_barrier
    ds_read_b128 a[208:211], v3 offset:24576
    ds_read_b128 a[212:215], v3 offset:25600
    ds_read_b128 a[216:219], v3 offset:26624
    ds_read_b128 a[220:223], v3 offset:27648
    ds_read_b128 a[224:227], v3 offset:28672
    ds_read_b128 a[228:231], v3 offset:29696
    ds_read_b128 a[232:235], v3 offset:30720
    s_waitcnt lgkmcnt(3)
    v_mfma_f32_16x16x32_bf16 v[128:131], a[208:211], a[0:3], 0
    s_add_u32 m0, s65, 122880
    s_add_u32 s47, s68, 32768
    v_mfma_f32_16x16x32_bf16 v[160:163], a[208:211], a[4:7], 0
    buffer_load_dwordx4 v2, s[32:35], s47 offen sc1 lds
    v_mfma_f32_16x16x32_bf16 v[132:135], a[212:215], a[0:3], 0
    ds_read_b128 a[236:239], v3 offset:31744
    v_mfma_f32_16x16x32_bf16 v[164:167], a[212:215], a[4:7], 0
    ds_read_b128 a[240:243], v4 offset:8192
    v_mfma_f32_16x16x32_bf16 v[136:139], a[216:219], a[0:3], 0
    ds_read_b128 a[244:247], v245 offset:24576
    v_mfma_f32_16x16x32_bf16 v[168:171], a[216:219], a[4:7], 0
    buffer_load_dwordx4 v8, s[32:35], s47 offen offset:1024 sc1 lds
    v_mfma_f32_16x16x32_bf16 v[140:143], a[220:223], a[0:3], 0
    s_mov_b32 s67, 360448
    ds_read_b128 a[248:251], v249 offset:24576
    v_mfma_f32_16x16x32_bf16 v[172:175], a[220:223], a[4:7], 0
    s_waitcnt lgkmcnt(4)
    buffer_store_dword v22, v103, s[32:35], s67 offen sc1
    v_mfma_f32_16x16x32_bf16 v[144:147], a[0:3], a[224:227], 0
    s_waitcnt vmcnt(7)
    s_barrier
    v_mfma_f32_16x16x32_bf16 v[176:179], a[4:7], a[224:227], 0
    s_add_u32 m0, s65, 131072
    ds_read_b128 a[252:255], v3 offset:32768
    ds_read_b128 a[208:211], v3 offset:33792
    v_mfma_f32_16x16x32_bf16 v[148:151], a[0:3], a[228:231], 0
    s_add_u32 s47, s68, 40960
    ds_read_b128 a[212:215], v3 offset:34816
    v_mfma_f32_16x16x32_bf16 v[180:183], a[4:7], a[228:231], 0
    buffer_load_dwordx4 v2, s[32:35], s47 offen sc1 lds
    v_mfma_f32_16x16x32_bf16 v[152:155], a[232:235], a[0:3], 0
    ds_read_b128 a[216:219], v3 offset:35840
    v_mfma_f32_16x16x32_bf16 v[184:187], a[232:235], a[4:7], 0
    s_waitcnt lgkmcnt(4)
    ds_read_b128 a[220:223], v3 offset:36864
    v_mfma_f32_16x16x32_bf16 v[156:159], a[0:3], a[236:239], 0
    v_mfma_f32_16x16x32_bf16 v[188:191], a[4:7], a[236:239], 0
    buffer_load_dwordx4 v8, s[32:35], s47 offen offset:1024 sc1 lds
    v_mfma_f32_16x16x32_bf16 v[192:195], a[244:247], a[240:243], 0
    ds_read_b128 a[224:227], v3 offset:37888
    v_mfma_f32_16x16x32_bf16 v[196:199], a[240:243], a[248:251], 0
    s_waitcnt lgkmcnt(3)
    ds_read_b128 a[228:231], v3 offset:38912
    v_mfma_f32_16x16x32_bf16 v[128:131], a[252:255], a[8:11], v[128:131]
    v_mfma_f32_16x16x32_bf16 v[160:163], a[252:255], a[12:15], v[160:163]
    buffer_load_dword v32, v37, s[32:35], s83 offen offset:0 sc1
    v_mfma_f32_16x16x32_bf16 v[132:135], a[208:211], a[8:11], v[132:135]
    buffer_store_dwordx4 v[40:43], v110, s[32:35], s40 offen sc1
    v_mfma_f32_16x16x32_bf16 v[164:167], a[208:211], a[12:15], v[164:167]
    ds_read_b128 a[232:235], v3 offset:39936
    v_mfma_f32_16x16x32_bf16 v[136:139], a[212:215], a[8:11], v[136:139]
    ds_read_b128 a[236:239], v4 offset:9216
    v_mfma_f32_16x16x32_bf16 v[168:171], a[212:215], a[12:15], v[168:171]
    s_waitcnt lgkmcnt(2)
    ds_read_b128 a[240:243], v245 offset:32768
    v_mfma_f32_16x16x32_bf16 v[140:143], a[216:219], a[8:11], v[140:143]
    ds_read_b128 a[244:247], v249 offset:32768
    v_mfma_f32_16x16x32_bf16 v[172:175], a[216:219], a[12:15], v[172:175]
    s_waitcnt vmcnt(9)
    s_barrier
    v_mfma_f32_16x16x32_bf16 v[144:147], a[8:11], a[220:223], v[144:147]
    ds_read_b128 a[248:251], v3 offset:40960
    v_mfma_f32_16x16x32_bf16 v[176:179], a[12:15], a[220:223], v[176:179]
    ds_read_b128 a[252:255], v3 offset:41984
    v_mfma_f32_16x16x32_bf16 v[148:151], a[8:11], a[224:227], v[148:151]
    buffer_load_dword v33, v37, s[32:35], s83 offen offset:320 sc1
    v_mfma_f32_16x16x32_bf16 v[180:183], a[12:15], a[224:227], v[180:183]
    buffer_load_dword v34, v37, s[32:35], s83 offen offset:640 sc1
    v_mfma_f32_16x16x32_bf16 v[152:155], a[228:231], a[8:11], v[152:155]
    ds_read_b128 a[208:211], v3 offset:43008
    v_mfma_f32_16x16x32_bf16 v[184:187], a[228:231], a[12:15], v[184:187]
L_pad1:
    s_cbranch_execz L_pad5
    s_waitcnt lgkmcnt(3)
    buffer_load_dword v35, v37, s[32:35], s83 offen offset:960 sc1
    v_mfma_f32_16x16x32_bf16 v[156:159], a[8:11], a[232:235], v[156:159]
    buffer_load_dword v36, v37, s[32:35], s83 offen offset:1280 sc1
    v_mfma_f32_16x16x32_bf16 v[188:191], a[12:15], a[232:235], v[188:191]
    s_add_u32 m0, s65, 0
    ds_read_b128 a[212:215], v3 offset:44032
    ds_read_b128 a[216:219], v3 offset:45056
    v_mfma_f32_16x16x32_bf16 v[192:195], a[240:243], a[236:239], v[192:195]
    s_add_u32 s47, s68, 49152
    ds_read_b128 a[220:223], v3 offset:46080
    v_mfma_f32_16x16x32_bf16 v[196:199], a[236:239], a[244:247], v[196:199]
    s_waitcnt lgkmcnt(4)
    buffer_load_dwordx4 v2, s[32:35], s47 offen sc1 lds
    v_mfma_f32_16x16x32_bf16 v[128:131], a[248:251], a[16:19], v[128:131]
    ds_read_b128 a[224:227], v3 offset:47104
    v_mfma_f32_16x16x32_bf16 v[160:163], a[248:251], a[20:23], v[160:163]
    ds_read_b128 a[228:231], v3 offset:48128
    v_mfma_f32_16x16x32_bf16 v[132:135], a[252:255], a[16:19], v[132:135]
    v_mfma_f32_16x16x32_bf16 v[164:167], a[252:255], a[20:23], v[164:167]
    s_waitcnt lgkmcnt(3)
    buffer_load_dwordx4 v8, s[32:35], s47 offen offset:1024 sc1 lds
    v_mfma_f32_16x16x32_bf16 v[136:139], a[208:211], a[16:19], v[136:139]
    ds_read_b128 a[232:235], v4 offset:10240
    v_mfma_f32_16x16x32_bf16 v[168:171], a[208:211], a[20:23], v[168:171]
    ds_read_b128 a[236:239], v245 offset:40960
    v_mfma_f32_16x16x32_bf16 v[140:143], a[212:215], a[16:19], v[140:143]
    ds_read_b128 a[240:243], v249 offset:40960
    v_mfma_f32_16x16x32_bf16 v[172:175], a[212:215], a[20:23], v[172:175]
    s_waitcnt vmcnt(13)
    s_barrier
    v_mfma_f32_16x16x32_bf16 v[144:147], a[16:19], a[216:219], v[144:147]
    buffer_store_dwordx4 v[44:47], v111, s[32:35], s40 offen sc1
    v_mfma_f32_16x16x32_bf16 v[176:179], a[20:23], a[216:219], v[176:179]
    s_waitcnt lgkmcnt(3)
    ds_read_b128 a[244:247], v3 offset:49152
    ds_read_b128 a[248:251], v3 offset:50176
    v_mfma_f32_16x16x32_bf16 v[148:151], a[16:19], a[220:223], v[148:151]
    ds_read_b128 a[252:255], v3 offset:51200
    v_mfma_f32_16x16x32_bf16 v[180:183], a[20:23], a[220:223], v[180:183]
    ds_read_b128 a[208:211], v3 offset:52224
    v_mfma_f32_16x16x32_bf16 v[152:155], a[224:227], a[16:19], v[152:155]
    v_mfma_f32_16x16x32_bf16 v[184:187], a[224:227], a[20:23], v[184:187]
    s_add_u32 m0, s65, 8192
    ds_read_b128 a[212:215], v3 offset:53248
    v_mfma_f32_16x16x32_bf16 v[156:159], a[16:19], a[228:231], v[156:159]
    s_add_u32 s47, s68, 57344
    v_mfma_f32_16x16x32_bf16 v[188:191], a[20:23], a[228:231], v[188:191]
    s_waitcnt lgkmcnt(3)
    buffer_load_dwordx4 v2, s[32:35], s47 offen sc1 lds
    v_mfma_f32_16x16x32_bf16 v[192:195], a[236:239], a[232:235], v[192:195]
    ds_read_b128 a[216:219], v3 offset:54272
    v_mfma_f32_16x16x32_bf16 v[196:199], a[232:235], a[240:243], v[196:199]
    ds_read_b128 a[220:223], v3 offset:55296
    v_mfma_f32_16x16x32_bf16 v[128:131], a[244:247], a[24:27], v[128:131]
    v_mfma_f32_16x16x32_bf16 v[160:163], a[244:247], a[28:31], v[160:163]
    buffer_load_dwordx4 v8, s[32:35], s47 offen offset:1024 sc1 lds
    v_mfma_f32_16x16x32_bf16 v[132:135], a[248:251], a[24:27], v[132:135]
    ds_read_b128 a[224:227], v3 offset:56320
    v_mfma_f32_16x16x32_bf16 v[164:167], a[248:251], a[28:31], v[164:167]
    s_waitcnt lgkmcnt(3)
    ds_read_b128 a[228:231], v4 offset:11264
    v_mfma_f32_16x16x32_bf16 v[136:139], a[252:255], a[24:27], v[136:139]
    ds_read_b128 a[232:235], v245 offset:49152
    v_mfma_f32_16x16x32_bf16 v[168:171], a[252:255], a[28:31], v[168:171]
    buffer_store_dwordx4 v[48:51], v112, s[32:35], s40 offen sc1
    v_mfma_f32_16x16x32_bf16 v[140:143], a[208:211], a[24:27], v[140:143]
    ds_read_b128 a[236:239], v249 offset:49152
    v_mfma_f32_16x16x32_bf16 v[172:175], a[208:211], a[28:31], v[172:175]
    s_waitcnt vmcnt(15)
    s_barrier
    v_mfma_f32_16x16x32_bf16 v[144:147], a[24:27], a[212:215], v[144:147]
    ds_read_b128 a[240:243], v3 offset:57344
    v_mfma_f32_16x16x32_bf16 v[176:179], a[28:31], a[212:215], v[176:179]
    s_waitcnt lgkmcnt(3)
    ds_read_b128 a[244:247], v3 offset:58368
    v_mfma_f32_16x16x32_bf16 v[148:151], a[24:27], a[216:219], v[148:151]
    ds_read_b128 a[248:251], v3 offset:59392
    v_mfma_f32_16x16x32_bf16 v[180:183], a[28:31], a[216:219], v[180:183]
    ds_read_b128 a[252:255], v3 offset:60416
    v_mfma_f32_16x16x32_bf16 v[152:155], a[220:223], a[24:27], v[152:155]
    v_mfma_f32_16x16x32_bf16 v[184:187], a[220:223], a[28:31], v[184:187]
    buffer_store_dwordx4 v[52:55], v113, s[32:35], s40 offen sc1
    v_mfma_f32_16x16x32_bf16 v[156:159], a[24:27], a[224:227], v[156:159]
    ds_read_b128 a[208:211], v3 offset:61440
    v_mfma_f32_16x16x32_bf16 v[188:191], a[28:31], a[224:227], v[188:191]
    s_waitcnt lgkmcnt(3)
    ds_read_b128 a[212:215], v3 offset:62464
    v_mfma_f32_16x16x32_bf16 v[192:195], a[232:235], a[228:231], v[192:195]
    v_mfma_f32_16x16x32_bf16 v[196:199], a[228:231], a[236:239], v[196:199]
    ds_read_b128 a[216:219], v3 offset:63488
    v_mfma_f32_16x16x32_bf16 v[128:131], a[240:243], a[32:35], v[128:131]
    s_add_u32 m0, s65, 16384
    s_add_u32 s47, s68, 65536
    v_mfma_f32_16x16x32_bf16 v[160:163], a[240:243], a[36:39], v[160:163]
    ds_read_b128 a[220:223], v3 offset:64512
    v_mfma_f32_16x16x32_bf16 v[132:135], a[244:247], a[32:35], v[132:135]
    buffer_load_dwordx4 v2, s[32:35], s47 offen sc1 lds
    v_mfma_f32_16x16x32_bf16 v[164:167], a[244:247], a[36:39], v[164:167]
    s_waitcnt lgkmcnt(2)
    ds_read_b128 a[224:227], v4 offset:12288
    v_mfma_f32_16x16x32_bf16 v[136:139], a[248:251], a[32:35], v[136:139]
    ds_read_b128 a[228:231], v245 offset:57344
    v_mfma_f32_16x16x32_bf16 v[168:171], a[248:251], a[36:39], v[168:171]
    ds_read_b128 a[232:235], v249 offset:57344
    v_mfma_f32_16x16x32_bf16 v[140:143], a[252:255], a[32:35], v[140:143]
    s_waitcnt vmcnt(14)
    s_barrier
    v_mfma_f32_16x16x32_bf16 v[172:175], a[252:255], a[36:39], v[172:175]
    buffer_load_dwordx4 v8, s[32:35], s47 offen offset:1024 sc1 lds
    v_mfma_f32_16x16x32_bf16 v[144:147], a[32:35], a[208:211], v[144:147]
    ds_read_b128 a[236:239], v4 offset:0
    v_mfma_f32_16x16x32_bf16 v[176:179], a[36:39], a[208:211], v[176:179]
    ds_read_b128 a[240:243], v4 offset:1024
    v_mfma_f32_16x16x32_bf16 v[148:151], a[32:35], a[212:215], v[148:151]
    ds_read_b128 a[244:247], v4 offset:2048
    v_mfma_f32_16x16x32_bf16 v[180:183], a[36:39], a[212:215], v[180:183]
    s_waitcnt lgkmcnt(3)
    buffer_store_dwordx4 v[56:59], v114, s[32:35], s40 offen sc1
    v_mfma_f32_16x16x32_bf16 v[152:155], a[216:219], a[32:35], v[152:155]
    ds_read_b128 a[248:251], v4 offset:3072
    v_mfma_f32_16x16x32_bf16 v[184:187], a[216:219], a[36:39], v[184:187]
    ds_read_b128 a[252:255], v4 offset:4096
    v_mfma_f32_16x16x32_bf16 v[156:159], a[32:35], a[220:223], v[156:159]
    v_mfma_f32_16x16x32_bf16 v[188:191], a[36:39], a[220:223], v[188:191]
    ds_read_b128 a[208:211], v4 offset:5120
    v_mfma_f32_16x16x32_bf16 v[192:195], a[228:231], a[224:227], v[192:195]
    s_add_u32 m0, s65, 24576
    s_add_u32 s47, s68, 73728
    v_mfma_f32_16x16x32_bf16 v[196:199], a[224:227], a[232:235], v[196:199]
    s_waitcnt lgkmcnt(3)
    ds_read_b128 a[212:215], v4 offset:6144
    v_mfma_f32_16x16x32_bf16 v[128:131], a[236:239], a[40:43], v[128:131]
    buffer_load_dwordx4 v2, s[32:35], s47 offen sc1 lds
    v_mfma_f32_16x16x32_bf16 v[160:163], a[236:239], a[44:47], v[160:163]
    ds_read_b128 a[216:219], v4 offset:7168
    v_mfma_f32_16x16x32_bf16 v[132:135], a[240:243], a[40:43], v[132:135]
    v_mfma_f32_16x16x32_bf16 v[164:167], a[240:243], a[44:47], v[164:167]
    ds_read_b128 a[220:223], v4 offset:13312
    v_mfma_f32_16x16x32_bf16 v[136:139], a[244:247], a[40:43], v[136:139]
    buffer_load_dwordx4 v8, s[32:35], s47 offen offset:1024 sc1 lds
    v_mfma_f32_16x16x32_bf16 v[168:171], a[244:247], a[44:47], v[168:171]
    s_waitcnt lgkmcnt(2)
    ds_read_b128 a[224:227], v246 offset:0
    v_mfma_f32_16x16x32_bf16 v[140:143], a[248:251], a[40:43], v[140:143]
    ds_read_b128 a[228:231], v250 offset:0
    v_mfma_f32_16x16x32_bf16 v[172:175], a[248:251], a[44:47], v[172:175]
    s_waitcnt vmcnt(10)
    s_barrier
    v_mfma_f32_16x16x32_bf16 v[144:147], a[40:43], a[252:255], v[144:147]
    buffer_store_dwordx4 v[72:75], v28, s[12:15], s93 offen sc1
    v_mfma_f32_16x16x32_bf16 v[176:179], a[44:47], a[252:255], v[176:179]
    ds_read_b128 a[232:235], v2 offset:0
    ds_read_b128 a[236:239], v2 offset:1024
    v_mfma_f32_16x16x32_bf16 v[148:151], a[40:43], a[208:211], v[148:151]
    ds_read_b128 a[240:243], v2 offset:2048
    v_mfma_f32_16x16x32_bf16 v[180:183], a[44:47], a[208:211], v[180:183]
    ds_read_b128 a[244:247], v2 offset:3072
    v_mfma_f32_16x16x32_bf16 v[152:155], a[212:215], a[40:43], v[152:155]
    v_mfma_f32_16x16x32_bf16 v[184:187], a[212:215], a[44:47], v[184:187]
    s_waitcnt lgkmcnt(4)
    ds_read_b128 a[248:251], v2 offset:4096
    v_mfma_f32_16x16x32_bf16 v[156:159], a[40:43], a[216:219], v[156:159]
    v_mfma_f32_16x16x32_bf16 v[188:191], a[44:47], a[216:219], v[188:191]
    ds_read_b128 a[252:255], v2 offset:5120
    v_mfma_f32_16x16x32_bf16 v[192:195], a[224:227], a[220:223], v[192:195]
    buffer_store_dwordx4 v[76:79], v29, s[12:15], s93 offen sc1
    v_mfma_f32_16x16x32_bf16 v[196:199], a[220:223], a[228:231], v[196:199]
    s_waitcnt lgkmcnt(2)
    ds_read_b128 a[208:211], v2 offset:6144
    v_mfma_f32_16x16x32_bf16 v[128:131], a[232:235], a[48:51], v[128:131]
    v_add_f32 v32, v32, v33
    v_add_f32 v32, v32, v34
    v_mfma_f32_16x16x32_bf16 v[160:163], a[232:235], a[52:55], v[160:163]
    ds_read_b128 a[212:215], v2 offset:7168
    v_add_f32 v32, v32, v35
    v_mfma_f32_16x16x32_bf16 v[132:135], a[236:239], a[48:51], v[132:135]
    v_add_f32 v32, v32, v36
    v_mov_b32 v33, v32
    v_mfma_f32_16x16x32_bf16 v[164:167], a[236:239], a[52:55], v[164:167]
    s_add_u32 m0, s65, 32768
    ds_read_b128 a[216:219], v4 offset:14336
    v_mfma_f32_16x16x32_bf16 v[136:139], a[240:243], a[48:51], v[136:139]
    s_add_u32 s47, s68, 81920
    ds_read_b128 a[220:223], v244 offset:0
    v_permlane32_swap_b32 v32, v33
    v_mfma_f32_16x16x32_bf16 v[168:171], a[240:243], a[52:55], v[168:171]
    buffer_load_dwordx4 v2, s[32:35], s47 offen sc1 lds
    v_mfma_f32_16x16x32_bf16 v[140:143], a[244:247], a[48:51], v[140:143]
    ds_read_b128 a[224:227], v248 offset:0
    v_add_f32 v32, v32, v33
    v_mfma_f32_16x16x32_bf16 v[172:175], a[244:247], a[52:55], v[172:175]
    s_waitcnt lgkmcnt(3)
    v_mfma_f32_16x16x32_bf16 v[144:147], a[48:51], a[248:251], v[144:147]
    s_waitcnt vmcnt(10)
    s_barrier
    v_mfma_f32_16x16x32_bf16 v[176:179], a[52:55], a[248:251], v[176:179]
    buffer_load_dwordx4 v8, s[32:35], s47 offen offset:1024 sc1 lds
    v_mfma_f32_16x16x32_bf16 v[148:151], a[48:51], a[252:255], v[148:151]
    ds_read_b128 a[228:231], v2 offset:8192
    ds_read_b128 a[232:235], v2 offset:9216
    v_mfma_f32_16x16x32_bf16 v[180:183], a[52:55], a[252:255], v[180:183]
    ds_read_b128 a[236:239], v2 offset:10240
    ds_write_b32 v38, v32
    v_mfma_f32_16x16x32_bf16 v[152:155], a[208:211], a[48:51], v[152:155]
    ds_read_b128 a[240:243], v2 offset:11264
    v_mfma_f32_16x16x32_bf16 v[184:187], a[208:211], a[52:55], v[184:187]
    ds_read_b128 a[244:247], v2 offset:12288
    v_mfma_f32_16x16x32_bf16 v[156:159], a[48:51], a[212:215], v[156:159]
    buffer_store_dwordx4 v[80:83], v84, s[12:15], s93 offen sc1
    v_mfma_f32_16x16x32_bf16 v[188:191], a[52:55], a[212:215], v[188:191]
    s_waitcnt lgkmcnt(6)
    ds_read_b128 a[248:251], v2 offset:13312
    v_mfma_f32_16x16x32_bf16 v[192:195], a[220:223], a[216:219], v[192:195]
    v_mfma_f32_16x16x32_bf16 v[196:199], a[216:219], a[224:227], v[196:199]
    s_waitcnt lgkmcnt(4)
    ds_read_b128 a[252:255], v2 offset:14336
    v_mfma_f32_16x16x32_bf16 v[128:131], a[228:231], a[56:59], v[128:131]
    s_mov_b32 s3, 360448
    v_mfma_f32_16x16x32_bf16 v[160:163], a[228:231], a[60:63], v[160:163]
    buffer_load_dword v39, v239, s[32:35], s3 offen sc1
    v_mfma_f32_16x16x32_bf16 v[132:135], a[232:235], a[56:59], v[132:135]
    s_add_u32 m0, s65, 40960
    ds_read_b128 a[208:211], v2 offset:15360
    v_mfma_f32_16x16x32_bf16 v[164:167], a[232:235], a[60:63], v[164:167]
    s_add_u32 s47, s68, 90112
    ds_read_b128 a[212:215], v4 offset:15360
    v_mfma_f32_16x16x32_bf16 v[136:139], a[236:239], a[56:59], v[136:139]
    s_waitcnt lgkmcnt(6)
    buffer_load_dwordx4 v2, s[32:35], s47 offen sc1 lds
    v_mfma_f32_16x16x32_bf16 v[168:171], a[236:239], a[60:63], v[168:171]
    s_waitcnt lgkmcnt(2)
    ds_read_b128 a[216:219], v244 offset:8192
    v_mfma_f32_16x16x32_bf16 v[140:143], a[240:243], a[56:59], v[140:143]
    ds_read_b128 a[220:223], v248 offset:8192
    v_mfma_f32_16x16x32_bf16 v[172:175], a[240:243], a[60:63], v[172:175]
    s_waitcnt vmcnt(10)
    s_barrier
    v_mfma_f32_16x16x32_bf16 v[144:147], a[56:59], a[244:247], v[144:147]
    buffer_load_dwordx4 v8, s[32:35], s47 offen offset:1024 sc1 lds
    v_mfma_f32_16x16x32_bf16 v[176:179], a[60:63], a[244:247], v[176:179]
    ds_read_b128 a[224:227], v2 offset:16384
    ds_read_b128 a[228:231], v2 offset:17408
    v_mfma_f32_16x16x32_bf16 v[148:151], a[56:59], a[248:251], v[148:151]
    ds_read_b128 a[232:235], v2 offset:18432
    v_mfma_f32_16x16x32_bf16 v[180:183], a[60:63], a[248:251], v[180:183]
    ds_read_b128 a[236:239], v2 offset:19456
    v_mfma_f32_16x16x32_bf16 v[152:155], a[252:255], a[56:59], v[152:155]
    buffer_store_dwordx4 v[64:67], v85, s[32:35], s43 offen offset:0 sc1
    v_mfma_f32_16x16x32_bf16 v[184:187], a[252:255], a[60:63], v[184:187]
    s_waitcnt lgkmcnt(4)
    ds_read_b128 a[240:243], v2 offset:20480
    v_mfma_f32_16x16x32_bf16 v[156:159], a[56:59], a[208:211], v[156:159]
    v_mfma_f32_16x16x32_bf16 v[188:191], a[60:63], a[208:211], v[188:191]
    ds_read_b128 a[244:247], v2 offset:21504
    v_mfma_f32_16x16x32_bf16 v[192:195], a[216:219], a[212:215], v[192:195]
    buffer_load_dwordx4 a[92:95], v7, s[32:35], s78 offen offset:3072 sc1
    v_mfma_f32_16x16x32_bf16 v[196:199], a[212:215], a[220:223], v[196:199]
    s_waitcnt lgkmcnt(2)
    ds_read_b128 a[248:251], v2 offset:22528
    v_mfma_f32_16x16x32_bf16 v[128:131], a[224:227], a[64:67], v[128:131]
    v_mfma_f32_16x16x32_bf16 v[160:163], a[224:227], a[68:71], v[160:163]
    ds_read_b128 a[252:255], v2 offset:23552
    ds_read_b128 v[200:203], v30 offset:0
    v_mfma_f32_16x16x32_bf16 v[132:135], a[228:231], a[64:67], v[132:135]
    buffer_store_dwordx4 v[68:71], v85, s[32:35], s43 offen offset:896 sc1
    v_mfma_f32_16x16x32_bf16 v[164:167], a[228:231], a[68:71], v[164:167]
    ds_read_b128 a[208:211], v4 offset:16384
    ds_read_b128 v[204:207], v30 offset:64
    v_mfma_f32_16x16x32_bf16 v[136:139], a[232:235], a[64:67], v[136:139]
    s_add_u32 m0, s75, 151552
    ds_read_b128 a[212:215], v244 offset:16384
    ds_read_b128 v[208:211], v30 offset:128
    v_mfma_f32_16x16x32_bf16 v[168:171], a[232:235], a[68:71], v[168:171]
    s_add_u32 s66, s49, 20480
    ds_read_b128 a[216:219], v248 offset:16384
    ds_read_b128 v[212:215], v30 offset:192
    v_mfma_f32_16x16x32_bf16 v[140:143], a[236:239], a[64:67], v[140:143]
    s_waitcnt vmcnt(11)
    s_barrier
    v_mfma_f32_16x16x32_bf16 v[172:175], a[236:239], a[68:71], v[172:175]
    s_waitcnt lgkmcnt(7)
    buffer_load_dwordx4 v2, s[32:35], s66 offen sc1 lds
    v_mfma_f32_16x16x32_bf16 v[144:147], a[64:67], a[240:243], v[144:147]
    ds_read_b128 a[220:223], v2 offset:24576
    ds_read_b32 v216, v31 offset:256
    v_mfma_f32_16x16x32_bf16 v[176:179], a[68:71], a[240:243], v[176:179]
    s_add_u32 m0, s65, 49152
    ds_read_b128 a[224:227], v2 offset:25600
    ds_read_b32 v220, v31 offset:320
    v_mfma_f32_16x16x32_bf16 v[148:151], a[64:67], a[244:247], v[148:151]
    s_add_u32 s47, s68, 98304
    ds_read_b128 a[228:231], v2 offset:26624
    ds_read_b128 v[224:227], v30 offset:384
    v_mfma_f32_16x16x32_bf16 v[180:183], a[68:71], a[244:247], v[180:183]
    buffer_load_dwordx4 v2, s[32:35], s47 offen sc1 lds
    v_mfma_f32_16x16x32_bf16 v[152:155], a[248:251], a[64:67], v[152:155]
    ds_read_b128 a[232:235], v2 offset:27648
    ds_read_b32 v228, v31 offset:448
    v_mfma_f32_16x16x32_bf16 v[184:187], a[248:251], a[68:71], v[184:187]
    s_waitcnt lgkmcnt(9)
    ds_read_b128 a[236:239], v2 offset:28672
    ds_read_b128 v[232:235], v247
    v_mfma_f32_16x16x32_bf16 v[156:159], a[64:67], a[252:255], v[156:159]
    ds_read_b32 v236, v251
    v_mfma_f32_16x16x32_bf16 v[188:191], a[68:71], a[252:255], v[188:191]
    buffer_load_dwordx4 v8, s[32:35], s47 offen offset:1024 sc1 lds
    v_mfma_f32_16x16x32_bf16 v[192:195], a[212:215], a[208:211], v[192:195]
    ds_read_b128 a[240:243], v2 offset:29696
    v_mfma_f32_16x16x32_bf16 v[196:199], a[208:211], a[216:219], v[196:199]
    s_waitcnt lgkmcnt(7)
    ds_read_b128 a[244:247], v2 offset:30720
    v_mfma_f32_16x16x32_bf16 v[128:131], a[220:223], a[72:75], v[128:131]
    s_add_u32 s78, s48, 20480
    s_waitcnt lgkmcnt(2)
    v_add_f32 v164, v164, v204
    v_mfma_f32_16x16x32_bf16 v[160:163], a[220:223], a[76:79], v[160:163]
    buffer_load_dwordx4 a[96:99], v2, s[32:35], s78 offen offset:0 sc1
    v_mfma_f32_16x16x32_bf16 v[132:135], a[224:227], a[72:75], v[132:135]
    ds_read_b128 a[248:251], v2 offset:31744
    v_add_f32 v168, v168, v208
    v_mfma_f32_16x16x32_bf16 v[164:167], a[224:227], a[76:79], v[164:167]
    ds_read_b128 a[252:255], v4 offset:17408
    v_add_f32 v128, v128, v200
    v_mfma_f32_16x16x32_bf16 v[136:139], a[228:231], a[72:75], v[136:139]
    ds_read_b128 a[208:211], v244 offset:24576
    v_add_f32 v160, v160, v200
    v_mfma_f32_16x16x32_bf16 v[168:171], a[228:231], a[76:79], v[168:171]
    buffer_load_dwordx4 a[100:103], v7, s[32:35], s78 offen offset:0 sc1
    v_mfma_f32_16x16x32_bf16 v[140:143], a[232:235], a[72:75], v[140:143]
    ds_read_b128 a[212:215], v248 offset:24576
    v_add_f32 v132, v132, v204
    v_mfma_f32_16x16x32_bf16 v[172:175], a[232:235], a[76:79], v[172:175]
    s_waitcnt vmcnt(12)
    s_barrier
    v_mfma_f32_16x16x32_bf16 v[144:147], a[72:75], a[236:239], v[144:147]
    s_add_u32 m0, s65, 57344
    ds_read_b128 a[216:219], v2 offset:32768
    v_add_f32 v136, v136, v208
    v_mfma_f32_16x16x32_bf16 v[176:179], a[76:79], a[236:239], v[176:179]
    s_waitcnt lgkmcnt(3)
    ds_read_b128 a[220:223], v2 offset:33792
    v_add_f32 v140, v140, v212
    v_mfma_f32_16x16x32_bf16 v[148:151], a[72:75], a[240:243], v[148:151]
    s_add_u32 s47, s68, 106496
    ds_read_b128 a[224:227], v2 offset:34816
    v_add_f32 v172, v172, v212
    v_mfma_f32_16x16x32_bf16 v[180:183], a[76:79], a[240:243], v[180:183]
    buffer_load_dwordx4 v2, s[32:35], s47 offen sc1 lds
    v_add_f32 v144, v144, v216
    v_mfma_f32_16x16x32_bf16 v[152:155], a[244:247], a[72:75], v[152:155]
    ds_read_b128 a[228:231], v2 offset:35840
    v_add_f32 v176, v176, v216
    v_mfma_f32_16x16x32_bf16 v[184:187], a[244:247], a[76:79], v[184:187]
    ds_read_b128 a[232:235], v2 offset:36864
    v_add_f32 v148, v148, v220
    v_mfma_f32_16x16x32_bf16 v[156:159], a[72:75], a[248:251], v[156:159]
    v_add_f32 v180, v180, v220
    v_add_f32 v196, v196, v236
    v_mfma_f32_16x16x32_bf16 v[188:191], a[76:79], a[248:251], v[188:191]
    s_waitcnt lgkmcnt(3)
    buffer_load_dwordx4 v8, s[32:35], s47 offen offset:1024 sc1 lds
    v_mfma_f32_16x16x32_bf16 v[192:195], a[208:211], a[252:255], v[192:195]
    ds_read_b128 a[236:239], v2 offset:37888
    v_add_f32 v152, v152, v224
    v_mfma_f32_16x16x32_bf16 v[196:199], a[252:255], a[212:215], v[196:199]
    ds_read_b128 a[240:243], v2 offset:38912
    v_add_f32 v184, v184, v224
    v_mfma_f32_16x16x32_bf16 v[128:131], a[216:219], a[80:83], v[128:131]
    s_waitcnt vmcnt(12)
    v_subrev_u32 v39, s64, v39
    v_cmp_lt_u32 vcc, 7, v39
    s_nop 0
    s_cbranch_vccz L_probed_20
    s_mov_b32 s67, 0
L_poll_21:
    s_mov_b32 s76, 360448
    buffer_load_dword v39, v239, s[32:35], s76 offen sc1
    s_waitcnt vmcnt(0)
    v_subrev_u32 v39, s64, v39
    v_cmp_lt_u32 vcc, 7, v39
    s_nop 0
    s_cbranch_vccz L_ready_22
    s_add_u32 s67, s67, 1
    s_cmp_lt_u32 s67, 20000
    s_cbranch_scc1 L_poll_21
L_ready_22:
L_probed_20:
    v_mfma_f32_16x16x32_bf16 v[160:163], a[216:219], a[84:87], v[160:163]
    buffer_load_dwordx4 a[104:107], v2, s[32:35], s78 offen offset:1024 sc1
    v_mfma_f32_16x16x32_bf16 v[132:135], a[220:223], a[80:83], v[132:135]
    ds_read_b128 a[244:247], v2 offset:39936
    v_add_f32 v156, v156, v228
    v_mfma_f32_16x16x32_bf16 v[164:167], a[220:223], a[84:87], v[164:167]
    s_waitcnt lgkmcnt(3)
    ds_read_b128 a[248:251], v4 offset:18432
    v_add_f32 v188, v188, v228
    v_mfma_f32_16x16x32_bf16 v[136:139], a[224:227], a[80:83], v[136:139]
    ds_read_b128 a[252:255], v244 offset:32768
    v_add_f32 v192, v192, v232
    v_mfma_f32_16x16x32_bf16 v[168:171], a[224:227], a[84:87], v[168:171]
    buffer_load_dwordx4 a[108:111], v7, s[32:35], s78 offen offset:1024 sc1
    v_mfma_f32_16x16x32_bf16 v[140:143], a[228:231], a[80:83], v[140:143]
    ds_read_b128 a[208:211], v248 offset:32768
    v_add_f32 v129, v129, v201
    v_mfma_f32_16x16x32_bf16 v[172:175], a[228:231], a[84:87], v[172:175]
    s_waitcnt vmcnt(12)
    s_barrier
    v_mfma_f32_16x16x32_bf16 v[144:147], a[80:83], a[232:235], v[144:147]
    s_add_u32 m0, s65, 65536
    ds_read_b128 a[212:215], v2 offset:40960
    v_add_f32 v161, v161, v201
    v_mfma_f32_16x16x32_bf16 v[176:179], a[84:87], a[232:235], v[176:179]
    s_waitcnt lgkmcnt(3)
    ds_read_b128 a[216:219], v2 offset:41984
    v_add_f32 v133, v133, v205
    v_mfma_f32_16x16x32_bf16 v[148:151], a[80:83], a[236:239], v[148:151]
    s_add_u32 s47, s68, 114688
    ds_read_b128 a[220:223], v2 offset:43008
    v_add_f32 v165, v165, v205
    v_mfma_f32_16x16x32_bf16 v[180:183], a[84:87], a[236:239], v[180:183]
    buffer_load_dwordx4 v2, s[32:35], s47 offen sc1 lds
    v_add_f32 v137, v137, v209
    v_mfma_f32_16x16x32_bf16 v[152:155], a[240:243], a[80:83], v[152:155]
    ds_read_b128 a[224:227], v2 offset:44032
    v_add_f32 v169, v169, v209
    v_mfma_f32_16x16x32_bf16 v[184:187], a[240:243], a[84:87], v[184:187]
    ds_read_b128 a[228:231], v2 offset:45056
    v_add_f32 v141, v141, v213
    v_mfma_f32_16x16x32_bf16 v[156:159], a[80:83], a[244:247], v[156:159]
    v_add_f32 v173, v173, v213
    v_add_f32 v145, v145, v216
    v_mfma_f32_16x16x32_bf16 v[188:191], a[84:87], a[244:247], v[188:191]
    s_waitcnt lgkmcnt(3)
    buffer_load_dwordx4 v8, s[32:35], s47 offen offset:1024 sc1 lds
    v_mfma_f32_16x16x32_bf16 v[192:195], a[252:255], a[248:251], v[192:195]
    ds_read_b128 a[232:235], v2 offset:46080
    v_add_f32 v177, v177, v216
    v_mfma_f32_16x16x32_bf16 v[196:199], a[248:251], a[208:211], v[196:199]
    s_waitcnt vmcnt(12) lgkmcnt(3)
    ds_read_b128 a[236:239], v2 offset:47104
    v_add_f32 v149, v149, v220
    v_mfma_f32_16x16x32_bf16 v[128:131], a[212:215], a[88:91], v[128:131]
    v_add_f32 v181, v181, v220
    v_add_f32 v153, v153, v225
    v_mfma_f32_16x16x32_bf16 v[160:163], a[212:215], a[92:95], v[160:163]
    buffer_load_dwordx4 a[112:115], v2, s[32:35], s78 offen offset:2048 sc1
    v_mfma_f32_16x16x32_bf16 v[132:135], a[216:219], a[88:91], v[132:135]
    s_waitcnt vmcnt(12)
    ds_read_b128 a[240:243], v2 offset:48128
    v_add_f32 v185, v185, v225
    v_mfma_f32_16x16x32_bf16 v[164:167], a[216:219], a[92:95], v[164:167]
    ds_read_b128 a[244:247], v4 offset:19456
    v_add_f32 v157, v157, v228
    v_mfma_f32_16x16x32_bf16 v[136:139], a[220:223], a[88:91], v[136:139]
    ds_read_b128 a[248:251], v244 offset:40960
    v_add_f32 v189, v189, v228
    v_mfma_f32_16x16x32_bf16 v[168:171], a[220:223], a[92:95], v[168:171]
    s_waitcnt lgkmcnt(3)
    buffer_load_dwordx4 a[116:119], v7, s[32:35], s78 offen offset:2048 sc1
    v_mfma_f32_16x16x32_bf16 v[140:143], a[224:227], a[88:91], v[140:143]
    ds_read_b128 a[252:255], v248 offset:40960
    v_add_f32 v193, v193, v233
    v_mfma_f32_16x16x32_bf16 v[172:175], a[224:227], a[92:95], v[172:175]
    s_waitcnt vmcnt(10)
    s_barrier
    v_mfma_f32_16x16x32_bf16 v[144:147], a[88:91], a[228:231], v[144:147]
    s_add_u32 m0, s65, 73728
    ds_read_b128 a[208:211], v2 offset:49152
    v_add_f32 v197, v197, v236
    v_mfma_f32_16x16x32_bf16 v[176:179], a[92:95], a[228:231], v[176:179]
    s_add_u32 s47, s68, 122880
    ds_read_b128 a[212:215], v2 offset:50176
    v_add_f32 v130, v130, v202
    v_mfma_f32_16x16x32_bf16 v[148:151], a[88:91], a[232:235], v[148:151]
    buffer_load_dwordx4 v2, s[32:35], s47 offen sc1 lds
    v_add_f32 v162, v162, v202
    v_mfma_f32_16x16x32_bf16 v[180:183], a[92:95], a[232:235], v[180:183]
    ds_read_b128 a[216:219], v2 offset:51200
    v_add_f32 v134, v134, v206
    v_mfma_f32_16x16x32_bf16 v[152:155], a[236:239], a[88:91], v[152:155]
    ds_read_b128 a[220:223], v2 offset:52224
    v_add_f32 v166, v166, v206
    v_mfma_f32_16x16x32_bf16 v[184:187], a[236:239], a[92:95], v[184:187]
    s_waitcnt lgkmcnt(4)
    ds_read_b128 a[224:227], v2 offset:53248
    v_add_f32 v138, v138, v210
    v_mfma_f32_16x16x32_bf16 v[156:159], a[88:91], a[240:243], v[156:159]
    buffer_load_dwordx4 v8, s[32:35], s47 offen offset:1024 sc1 lds
    v_add_f32 v170, v170, v210
    v_mfma_f32_16x16x32_bf16 v[188:191], a[92:95], a[240:243], v[188:191]
    ds_read_b128 a[228:231], v2 offset:54272
    v_add_f32 v142, v142, v214
    v_mfma_f32_16x16x32_bf16 v[192:195], a[248:251], a[244:247], v[192:195]
    v_add_f32 v174, v174, v214
    v_add_f32 v146, v146, v216
    v_mfma_f32_16x16x32_bf16 v[196:199], a[244:247], a[252:255], v[196:199]
    s_waitcnt vmcnt(10) lgkmcnt(3)
    ds_read_b128 a[232:235], v2 offset:55296
    v_add_f32 v178, v178, v216
    v_mfma_f32_16x16x32_bf16 v[128:131], a[208:211], a[96:99], v[128:131]
    buffer_load_dwordx4 a[120:123], v2, s[32:35], s78 offen offset:3072 sc1
    v_mfma_f32_16x16x32_bf16 v[160:163], a[208:211], a[100:103], v[160:163]
    ds_read_b128 a[236:239], v2 offset:56320
    v_add_u32 v22, 1, v22
    v_mfma_f32_16x16x32_bf16 v[132:135], a[212:215], a[96:99], v[132:135]
    s_mov_b32 s67, 360448
    v_mfma_f32_16x16x32_bf16 v[164:167], a[212:215], a[100:103], v[164:167]
    buffer_store_dword v22, v103, s[32:35], s67 offen sc1
    v_mfma_f32_16x16x32_bf16 v[136:139], a[216:219], a[96:99], v[136:139]
    buffer_load_dwordx4 a[124:127], v7, s[32:35], s78 offen offset:3072 sc1
    v_mfma_f32_16x16x32_bf16 v[168:171], a[216:219], a[100:103], v[168:171]
    s_waitcnt lgkmcnt(1)
    ds_read_b128 a[240:243], v4 offset:20480
    ds_read_b128 a[244:247], v244 offset:49152
    v_mfma_f32_16x16x32_bf16 v[140:143], a[220:223], a[96:99], v[140:143]
    s_add_u32 m0, s75, 155648
    ds_read_b128 a[248:251], v248 offset:49152
    v_add_f32 v150, v150, v220
    v_mfma_f32_16x16x32_bf16 v[172:175], a[220:223], a[100:103], v[172:175]
    s_waitcnt vmcnt(11)
    s_barrier
    v_mfma_f32_16x16x32_bf16 v[144:147], a[96:99], a[224:227], v[144:147]
    s_add_u32 s66, s49, 32768
    ds_read_b128 a[252:255], v2 offset:57344
    v_add_f32 v182, v182, v220
    v_mfma_f32_16x16x32_bf16 v[176:179], a[100:103], a[224:227], v[176:179]
    buffer_load_dwordx4 v2, s[32:35], s66 offen sc1 lds
    v_add_f32 v154, v154, v226
    v_mfma_f32_16x16x32_bf16 v[148:151], a[96:99], a[228:231], v[148:151]
    ds_read_b128 a[208:211], v2 offset:58368
    v_add_f32 v186, v186, v226
    v_mfma_f32_16x16x32_bf16 v[180:183], a[100:103], a[228:231], v[180:183]
    s_add_u32 m0, s65, 81920
    ds_read_b128 a[212:215], v2 offset:59392
    v_add_f32 v158, v158, v228
    v_mfma_f32_16x16x32_bf16 v[152:155], a[232:235], a[96:99], v[152:155]
    s_add_u32 s47, s68, 131072
    ds_read_b128 a[216:219], v2 offset:60416
    v_add_f32 v190, v190, v228
    v_mfma_f32_16x16x32_bf16 v[184:187], a[232:235], a[100:103], v[184:187]
    s_waitcnt lgkmcnt(4)
    buffer_load_dwordx4 v2, s[32:35], s47 offen sc1 lds
    v_mfma_f32_16x16x32_bf16 v[156:159], a[96:99], a[236:239], v[156:159]
    ds_read_b128 a[220:223], v2 offset:61440
    v_add_f32 v198, v198, v236
    v_mfma_f32_16x16x32_bf16 v[188:191], a[100:103], a[236:239], v[188:191]
    ds_read_b128 a[224:227], v2 offset:62464
    v_add_f32 v131, v131, v203
    v_mfma_f32_16x16x32_bf16 v[192:195], a[244:247], a[240:243], v[192:195]
    v_add_f32 v163, v163, v203
    v_add_f32 v135, v135, v207
    v_mfma_f32_16x16x32_bf16 v[196:199], a[240:243], a[248:251], v[196:199]
    s_waitcnt vmcnt(11) lgkmcnt(3)
    buffer_load_dwordx4 v8, s[32:35], s47 offen offset:1024 sc1 lds
    v_mfma_f32_16x16x32_bf16 v[128:131], a[252:255], a[104:107], v[128:131]
    ds_read_b128 a[228:231], v2 offset:63488
    v_add_f32 v167, v167, v207
    v_mfma_f32_16x16x32_bf16 v[160:163], a[252:255], a[108:111], v[160:163]
    s_add_u32 s78, s48, 32768
    ds_read_b128 a[232:235], v2 offset:64512
    v_add_f32 v194, v194, v234
    v_mfma_f32_16x16x32_bf16 v[132:135], a[208:211], a[104:107], v[132:135]
    v_add_f32 v171, v171, v211
    v_add_f32 v143, v143, v215
    v_mfma_f32_16x16x32_bf16 v[164:167], a[208:211], a[108:111], v[164:167]
    buffer_load_dwordx4 a[128:131], v2, s[32:35], s78 offen offset:0 sc1
    v_mfma_f32_16x16x32_bf16 v[136:139], a[212:215], a[104:107], v[136:139]
    ds_read_b128 a[236:239], v4 offset:21504
    v_add_f32 v175, v175, v215
    v_mfma_f32_16x16x32_bf16 v[168:171], a[212:215], a[108:111], v[168:171]
    s_waitcnt lgkmcnt(3)
    ds_read_b128 a[240:243], v244 offset:57344
    v_add_f32 v147, v147, v216
    v_mfma_f32_16x16x32_bf16 v[140:143], a[216:219], a[104:107], v[140:143]
    ds_read_b128 a[244:247], v248 offset:57344
    v_add_f32 v139, v139, v211
    v_mfma_f32_16x16x32_bf16 v[172:175], a[216:219], a[108:111], v[172:175]
    s_waitcnt vmcnt(11)
    s_barrier
    v_mfma_f32_16x16x32_bf16 v[144:147], a[104:107], a[220:223], v[144:147]
    buffer_load_dwordx4 a[132:135], v7, s[32:35], s78 offen offset:0 sc1
    v_mfma_f32_16x16x32_bf16 v[176:179], a[108:111], a[220:223], v[176:179]
    ds_read_b128 a[248:251], v3 offset:0
    ds_read_b128 a[252:255], v3 offset:1024
    v_mfma_f32_16x16x32_bf16 v[148:151], a[104:107], a[224:227], v[148:151]
    s_add_u32 m0, s65, 90112
    ds_read_b128 a[208:211], v3 offset:2048
    v_add_f32 v187, v187, v227
L_pad2:
    s_cbranch_execz L_pad6
    v_mfma_f32_16x16x32_bf16 v[180:183], a[108:111], a[224:227], v[180:183]
    s_waitcnt lgkmcnt(4)
    ds_read_b128 a[212:215], v3 offset:3072
    v_add_f32 v179, v179, v216
    v_mfma_f32_16x16x32_bf16 v[152:155], a[228:231], a[104:107], v[152:155]
    s_add_u32 s47, s68, 139264
    v_add_f32 v151, v151, v220
    v_add_f32 v191, v191, v228
    v_mfma_f32_16x16x32_bf16 v[184:187], a[228:231], a[108:111], v[184:187]
    buffer_load_dwordx4 v2, s[32:35], s47 offen sc1 lds
    v_add_f32 v183, v183, v220
    v_mfma_f32_16x16x32_bf16 v[156:159], a[104:107], a[232:235], v[156:159]
    ds_read_b128 a[216:219], v3 offset:4096
    v_add_f32 v155, v155, v227
    v_mfma_f32_16x16x32_bf16 v[188:191], a[108:111], a[232:235], v[188:191]
    ds_read_b128 a[220:223], v3 offset:5120
    v_mfma_f32_16x16x32_bf16 v[192:195], a[240:243], a[236:239], v[192:195]
    s_waitcnt lgkmcnt(3)
    v_mfma_f32_16x16x32_bf16 v[196:199], a[236:239], a[244:247], v[196:199]
    s_waitcnt vmcnt(11) lgkmcnt(2)
    buffer_load_dwordx4 v8, s[32:35], s47 offen offset:1024 sc1 lds
    v_mfma_f32_16x16x32_bf16 v[128:131], a[248:251], a[112:115], v[128:131]
    ds_read_b128 a[224:227], v3 offset:6144
    v_add_f32 v159, v159, v228
    v_mfma_f32_16x16x32_bf16 v[160:163], a[248:251], a[116:119], v[160:163]
    ds_read_b128 a[228:231], v3 offset:7168
    v_add_f32 v195, v195, v235
    v_mfma_f32_16x16x32_bf16 v[132:135], a[252:255], a[112:115], v[132:135]
    v_add_f32 v199, v199, v236
    v_mfma_f32_16x16x32_bf16 v[164:167], a[252:255], a[116:119], v[164:167]
    buffer_load_dwordx4 a[136:139], v2, s[32:35], s78 offen offset:1024 sc1
    v_mfma_f32_16x16x32_bf16 v[136:139], a[208:211], a[112:115], v[136:139]
    ds_read_b128 a[232:235], v4 offset:22528
    v_mfma_f32_16x16x32_bf16 v[168:171], a[208:211], a[116:119], v[168:171]
    ds_read_b128 a[236:239], v245 offset:0
    v_mfma_f32_16x16x32_bf16 v[140:143], a[212:215], a[112:115], v[140:143]
    ds_read_b128 a[240:243], v249 offset:0
    v_mfma_f32_16x16x32_bf16 v[172:175], a[212:215], a[116:119], v[172:175]
    s_waitcnt lgkmcnt(3)
    buffer_load_dwordx4 a[140:143], v7, s[32:35], s78 offen offset:1024 sc1
    v_mfma_f32_16x16x32_bf16 v[144:147], a[112:115], a[216:219], v[144:147]
    s_waitcnt vmcnt(12)
    s_barrier
    v_mfma_f32_16x16x32_bf16 v[176:179], a[116:119], a[216:219], v[176:179]
    s_add_u32 m0, s65, 98304
    ds_read_b128 a[244:247], v3 offset:8192
    ds_read_b128 a[248:251], v3 offset:9216
    v_mfma_f32_16x16x32_bf16 v[148:151], a[112:115], a[220:223], v[148:151]
    s_add_u32 s47, s68, 147456
    ds_read_b128 a[252:255], v3 offset:10240
    v_mfma_f32_16x16x32_bf16 v[180:183], a[116:119], a[220:223], v[180:183]
    buffer_load_dwordx4 v2, s[32:35], s47 offen sc1 lds
    v_mfma_f32_16x16x32_bf16 v[152:155], a[224:227], a[112:115], v[152:155]
    ds_read_b128 a[208:211], v3 offset:11264
    v_mfma_f32_16x16x32_bf16 v[184:187], a[224:227], a[116:119], v[184:187]
    ds_read_b128 a[212:215], v3 offset:12288
    v_mfma_f32_16x16x32_bf16 v[156:159], a[112:115], a[228:231], v[156:159]
    v_mfma_f32_16x16x32_bf16 v[188:191], a[116:119], a[228:231], v[188:191]
    s_waitcnt lgkmcnt(3)
    buffer_load_dwordx4 v8, s[32:35], s47 offen offset:1024 sc1 lds
    v_mfma_f32_16x16x32_bf16 v[192:195], a[236:239], a[232:235], v[192:195]
    ds_read_b128 a[216:219], v3 offset:13312
    v_mfma_f32_16x16x32_bf16 v[196:199], a[232:235], a[240:243], v[196:199]
    s_waitcnt vmcnt(11) lgkmcnt(3)
    ds_read_b128 a[220:223], v3 offset:14336
    v_mfma_f32_16x16x32_bf16 v[128:131], a[244:247], a[120:123], v[128:131]
    v_mfma_f32_16x16x32_bf16 v[160:163], a[244:247], a[124:127], v[160:163]
    buffer_load_dwordx4 a[144:147], v2, s[32:35], s78 offen offset:2048 sc1
    v_mfma_f32_16x16x32_bf16 v[132:135], a[248:251], a[120:123], v[132:135]
    ds_read_b128 a[224:227], v3 offset:15360
    v_mfma_f32_16x16x32_bf16 v[164:167], a[248:251], a[124:127], v[164:167]
    ds_read_b128 a[228:231], v4 offset:23552
    v_mfma_f32_16x16x32_bf16 v[136:139], a[252:255], a[120:123], v[136:139]
    ds_read_b128 a[232:235], v245 offset:8192
    v_mfma_f32_16x16x32_bf16 v[168:171], a[252:255], a[124:127], v[168:171]
    s_waitcnt lgkmcnt(3)
    buffer_load_dwordx4 a[148:151], v7, s[32:35], s78 offen offset:2048 sc1
    v_mfma_f32_16x16x32_bf16 v[140:143], a[208:211], a[120:123], v[140:143]
    ds_read_b128 a[236:239], v249 offset:8192
    v_mfma_f32_16x16x32_bf16 v[172:175], a[208:211], a[124:127], v[172:175]
    s_waitcnt vmcnt(10)
    s_barrier
    v_mfma_f32_16x16x32_bf16 v[144:147], a[120:123], a[212:215], v[144:147]
    s_add_u32 m0, s65, 106496
    ds_read_b128 a[240:243], v3 offset:16384
    v_mfma_f32_16x16x32_bf16 v[176:179], a[124:127], a[212:215], v[176:179]
    s_add_u32 s47, s68, 155648
    ds_read_b128 a[244:247], v3 offset:17408
    v_mfma_f32_16x16x32_bf16 v[148:151], a[120:123], a[216:219], v[148:151]
    buffer_load_dwordx4 v2, s[32:35], s47 offen sc1 lds
    v_mfma_f32_16x16x32_bf16 v[180:183], a[124:127], a[216:219], v[180:183]
    ds_read_b128 a[248:251], v3 offset:18432
    v_mfma_f32_16x16x32_bf16 v[152:155], a[220:223], a[120:123], v[152:155]
    ds_read_b128 a[252:255], v3 offset:19456
    v_mfma_f32_16x16x32_bf16 v[184:187], a[220:223], a[124:127], v[184:187]
    s_waitcnt lgkmcnt(4)
    ds_read_b128 a[208:211], v3 offset:20480
    v_mfma_f32_16x16x32_bf16 v[156:159], a[120:123], a[224:227], v[156:159]
    buffer_load_dwordx4 v8, s[32:35], s47 offen offset:1024 sc1 lds
    v_mfma_f32_16x16x32_bf16 v[188:191], a[124:127], a[224:227], v[188:191]
    ds_read_b128 a[212:215], v3 offset:21504
    v_mfma_f32_16x16x32_bf16 v[192:195], a[232:235], a[228:231], v[192:195]
    v_mfma_f32_16x16x32_bf16 v[196:199], a[228:231], a[236:239], v[196:199]
    s_waitcnt vmcnt(10) lgkmcnt(3)
    ds_read_b128 a[216:219], v3 offset:22528
    v_mfma_f32_16x16x32_bf16 v[128:131], a[240:243], a[128:131], v[128:131]
    buffer_load_dwordx4 a[152:155], v2, s[32:35], s78 offen offset:3072 sc1
    v_mfma_f32_16x16x32_bf16 v[160:163], a[240:243], a[132:135], v[160:163]
    ds_read_b128 a[220:223], v3 offset:23552
    v_mfma_f32_16x16x32_bf16 v[132:135], a[244:247], a[128:131], v[132:135]
    v_mfma_f32_16x16x32_bf16 v[164:167], a[244:247], a[132:135], v[164:167]
    ds_read_b128 a[224:227], v4 offset:24576
    v_mfma_f32_16x16x32_bf16 v[136:139], a[248:251], a[128:131], v[136:139]
    buffer_load_dwordx4 a[156:159], v7, s[32:35], s78 offen offset:3072 sc1
    v_mfma_f32_16x16x32_bf16 v[168:171], a[248:251], a[132:135], v[168:171]
    s_waitcnt lgkmcnt(2)
    ds_read_b128 a[228:231], v245 offset:16384
    v_mfma_f32_16x16x32_bf16 v[140:143], a[252:255], a[128:131], v[140:143]
    ds_read_b128 a[232:235], v249 offset:16384
    v_mfma_f32_16x16x32_bf16 v[172:175], a[252:255], a[132:135], v[172:175]
    s_waitcnt vmcnt(10)
    s_barrier
    v_mfma_f32_16x16x32_bf16 v[144:147], a[128:131], a[208:211], v[144:147]
    buffer_load_dwordx4 v[12:15], v252, s[28:31], s94 offen
    v_mfma_f32_16x16x32_bf16 v[176:179], a[132:135], a[208:211], v[176:179]
    ds_read_b128 a[236:239], v3 offset:24576
    ds_read_b128 a[240:243], v3 offset:25600
    v_mfma_f32_16x16x32_bf16 v[148:151], a[128:131], a[212:215], v[148:151]
    ds_read_b128 a[244:247], v3 offset:26624
    v_mfma_f32_16x16x32_bf16 v[180:183], a[132:135], a[212:215], v[180:183]
    ds_read_b128 a[248:251], v3 offset:27648
    v_mfma_f32_16x16x32_bf16 v[152:155], a[216:219], a[128:131], v[152:155]
    v_mfma_f32_16x16x32_bf16 v[184:187], a[216:219], a[132:135], v[184:187]
    s_waitcnt lgkmcnt(4)
    ds_read_b128 a[252:255], v3 offset:28672
    v_mfma_f32_16x16x32_bf16 v[156:159], a[128:131], a[220:223], v[156:159]
    buffer_load_dwordx4 v[16:19], v252, s[28:31], s94 offen offset:64
    v_mfma_f32_16x16x32_bf16 v[188:191], a[132:135], a[220:223], v[188:191]
    ds_read_b128 a[208:211], v3 offset:29696
    v_mfma_f32_16x16x32_bf16 v[192:195], a[228:231], a[224:227], v[192:195]
    v_mfma_f32_16x16x32_bf16 v[196:199], a[224:227], a[232:235], v[196:199]
    s_waitcnt vmcnt(10) lgkmcnt(2)
    ds_read_b128 a[212:215], v3 offset:30720
    v_mfma_f32_16x16x32_bf16 v[128:131], a[236:239], a[136:139], v[128:131]
    v_mfma_f32_16x16x32_bf16 v[160:163], a[236:239], a[140:143], v[160:163]
    ds_read_b128 a[216:219], v3 offset:31744
    v_mfma_f32_16x16x32_bf16 v[132:135], a[240:243], a[136:139], v[132:135]
    buffer_load_dwordx2 v[20:21], v253, s[28:31], s94 offen offset:128
    v_mfma_f32_16x16x32_bf16 v[164:167], a[240:243], a[140:143], v[164:167]
    ds_read_b128 a[220:223], v4 offset:25600
    v_mfma_f32_16x16x32_bf16 v[136:139], a[244:247], a[136:139], v[136:139]
    ds_read_b128 a[224:227], v245 offset:24576
    v_mfma_f32_16x16x32_bf16 v[168:171], a[244:247], a[140:143], v[168:171]
    ds_read_b128 a[228:231], v249 offset:24576
    v_mfma_f32_16x16x32_bf16 v[140:143], a[248:251], a[136:139], v[140:143]
    s_waitcnt vmcnt(9)
    s_barrier
    v_mfma_f32_16x16x32_bf16 v[172:175], a[248:251], a[140:143], v[172:175]
    s_waitcnt lgkmcnt(3)
    ds_read_b128 a[232:235], v3 offset:32768
    v_mfma_f32_16x16x32_bf16 v[144:147], a[136:139], a[252:255], v[144:147]
    s_add_u32 m0, s65, 114688
    ds_read_b128 a[236:239], v3 offset:33792
    v_mfma_f32_16x16x32_bf16 v[176:179], a[140:143], a[252:255], v[176:179]
    s_add_u32 s47, s69, 0
    ds_read_b128 a[240:243], v3 offset:34816
    v_mfma_f32_16x16x32_bf16 v[148:151], a[136:139], a[208:211], v[148:151]
    buffer_load_dwordx4 v2, s[32:35], s47 offen sc1 lds
    v_mfma_f32_16x16x32_bf16 v[180:183], a[140:143], a[208:211], v[180:183]
    ds_read_b128 a[244:247], v3 offset:35840
    v_mfma_f32_16x16x32_bf16 v[152:155], a[212:215], a[136:139], v[152:155]
    v_mfma_f32_16x16x32_bf16 v[184:187], a[212:215], a[140:143], v[184:187]
    ds_read_b128 a[248:251], v3 offset:36864
    v_mfma_f32_16x16x32_bf16 v[156:159], a[136:139], a[216:219], v[156:159]
    buffer_load_dwordx4 v2, s[32:35], s47 offen offset:1024 sc1 lds
    v_mfma_f32_16x16x32_bf16 v[188:191], a[140:143], a[216:219], v[188:191]
    s_waitcnt lgkmcnt(2)
    ds_read_b128 a[252:255], v3 offset:37888
    v_mfma_f32_16x16x32_bf16 v[192:195], a[224:227], a[220:223], v[192:195]
    s_add_u32 m0, s65, 122880
    s_add_u32 s47, s69, 8192
    v_mfma_f32_16x16x32_bf16 v[196:199], a[220:223], a[228:231], v[196:199]
    s_waitcnt vmcnt(9) lgkmcnt(2)
    ds_read_b128 a[208:211], v3 offset:38912
    v_mfma_f32_16x16x32_bf16 v[128:131], a[232:235], a[144:147], v[128:131]
    buffer_load_dwordx4 v2, s[32:35], s47 offen sc1 lds
    v_mfma_f32_16x16x32_bf16 v[160:163], a[232:235], a[148:151], v[160:163]
    ds_read_b128 a[212:215], v3 offset:39936
    v_mfma_f32_16x16x32_bf16 v[132:135], a[236:239], a[144:147], v[132:135]
    s_mov_b32 s3, 360448
    v_mfma_f32_16x16x32_bf16 v[164:167], a[236:239], a[148:151], v[164:167]
    buffer_load_dword v39, v11, s[32:35], s3 offen sc1
    v_mfma_f32_16x16x32_bf16 v[136:139], a[240:243], a[144:147], v[136:139]
    buffer_load_dwordx4 v2, s[32:35], s47 offen offset:1024 sc1 lds
    v_mfma_f32_16x16x32_bf16 v[168:171], a[240:243], a[148:151], v[168:171]
    ds_read_b128 a[216:219], v4 offset:26624
    ds_read_b128 a[220:223], v245 offset:32768
    v_mfma_f32_16x16x32_bf16 v[140:143], a[244:247], a[144:147], v[140:143]
    s_add_u32 m0, s65, 131072
    ds_read_b128 a[224:227], v249 offset:32768
    v_mfma_f32_16x16x32_bf16 v[172:175], a[244:247], a[148:151], v[172:175]
    s_waitcnt lgkmcnt(3)
    s_add_u32 s47, s69, 16384
    v_mfma_f32_16x16x32_bf16 v[144:147], a[144:147], a[248:251], v[144:147]
    s_waitcnt vmcnt(10)
    s_barrier
    v_mfma_f32_16x16x32_bf16 v[176:179], a[148:151], a[248:251], v[176:179]
    buffer_load_dwordx4 v2, s[32:35], s47 offen sc1 lds
    v_mfma_f32_16x16x32_bf16 v[148:151], a[144:147], a[252:255], v[148:151]
    ds_read_b128 a[228:231], v4 offset:27648
    ds_read_b128 a[232:235], v245 offset:40960
    v_mfma_f32_16x16x32_bf16 v[180:183], a[148:151], a[252:255], v[180:183]
    ds_read_b128 a[236:239], v249 offset:40960
    ds_read_b128 a[240:243], v3 offset:40960
    v_mfma_f32_16x16x32_bf16 v[152:155], a[208:211], a[144:147], v[152:155]
    ds_read_b128 a[244:247], v3 offset:41984
    ds_read_b128 a[248:251], v3 offset:47104
    v_mfma_f32_16x16x32_bf16 v[184:187], a[208:211], a[148:151], v[184:187]
    buffer_load_dwordx4 v2, s[32:35], s47 offen offset:1024 sc1 lds
    v_mfma_f32_16x16x32_bf16 v[156:159], a[144:147], a[212:215], v[156:159]
    ds_read_b128 a[252:255], v3 offset:45056
    ds_read_b128 a[208:211], v3 offset:46080
    v_mfma_f32_16x16x32_bf16 v[188:191], a[148:151], a[212:215], v[188:191]
    s_waitcnt lgkmcnt(8)
    ds_read_b128 a[212:215], v3 offset:48128
    v_mfma_f32_16x16x32_bf16 v[192:195], a[220:223], a[216:219], v[192:195]
    s_add_u32 m0, s65, 0
    s_add_u32 s47, s69, 24576
    v_mfma_f32_16x16x32_bf16 v[196:199], a[216:219], a[224:227], v[196:199]
    s_waitcnt lgkmcnt(5)
    buffer_load_dwordx4 v2, s[32:35], s47 offen sc1 lds
    v_mfma_f32_16x16x32_bf16 v[192:195], a[232:235], a[228:231], v[192:195]
    ds_read_b128 a[216:219], v3 offset:43008
    ds_read_b128 a[220:223], v3 offset:44032
    v_mfma_f32_16x16x32_bf16 v[196:199], a[228:231], a[236:239], v[196:199]
    s_waitcnt vmcnt(11) lgkmcnt(5)
    v_mfma_f32_16x16x32_bf16 v[160:163], a[240:243], a[156:159], v[160:163]
    v_mfma_f32_16x16x32_bf16 v[164:167], a[244:247], a[156:159], v[164:167]
    buffer_load_dwordx4 v2, s[32:35], s47 offen offset:1024 sc1 lds
    v_mfma_f32_16x16x32_bf16 v[184:187], a[248:251], a[156:159], v[184:187]
    s_waitcnt lgkmcnt(2)
    v_mfma_f32_16x16x32_bf16 v[176:179], a[156:159], a[252:255], v[176:179]
    s_add_u32 m0, s65, 8192
    s_add_u32 s47, s69, 32768
    v_cvt_pk_bf16_f32 v120, v192, v193
    v_mfma_f32_16x16x32_bf16 v[180:183], a[156:159], a[208:211], v[180:183]
    v_cvt_pk_bf16_f32 v121, v194, v195
    v_mfma_f32_16x16x32_bf16 v[188:191], a[156:159], a[212:215], v[188:191]
    buffer_load_dwordx4 v2, s[32:35], s47 offen sc1 lds
    v_mfma_f32_16x16x32_bf16 v[152:155], a[248:251], a[152:155], v[152:155]
    s_waitcnt lgkmcnt(0)
    ds_write_b64 v97, v[120:121]
    v_cvt_pk_bf16_f32 v122, v196, v197
    v_mfma_f32_16x16x32_bf16 v[168:171], a[216:219], a[156:159], v[168:171]
    v_cvt_pk_bf16_f32 v123, v198, v199
    v_mfma_f32_16x16x32_bf16 v[172:175], a[220:223], a[156:159], v[172:175]
    ds_write_b64 v97, v[122:123] offset:1536
    v_cvt_pk_bf16_f32 v212, v160, v161
    v_mfma_f32_16x16x32_bf16 v[128:131], a[240:243], a[152:155], v[128:131]
    buffer_load_dwordx4 v2, s[32:35], s47 offen offset:1024 sc1 lds
    v_cvt_pk_bf16_f32 v213, v162, v163
    v_mfma_f32_16x16x32_bf16 v[132:135], a[244:247], a[152:155], v[132:135]
    ds_write_b64 v96, v[212:213] offset:3072
    v_cvt_pk_bf16_f32 v216, v164, v165
    v_mfma_f32_16x16x32_bf16 v[136:139], a[216:219], a[152:155], v[136:139]
    s_add_u32 m0, s65, 16384
    s_add_u32 s47, s69, 40960
    v_cvt_pk_bf16_f32 v217, v166, v167
    v_mfma_f32_16x16x32_bf16 v[140:143], a[220:223], a[152:155], v[140:143]
    ds_write_b64 v96, v[216:217] offset:3584
    v_cvt_pk_bf16_f32 v214, v184, v185
    v_mfma_f32_16x16x32_bf16 v[144:147], a[152:155], a[252:255], v[144:147]
    buffer_load_dwordx4 v2, s[32:35], s47 offen sc1 lds
    v_cvt_pk_bf16_f32 v215, v186, v187
    v_mfma_f32_16x16x32_bf16 v[148:151], a[152:155], a[208:211], v[148:151]
    ds_write_b64 v96, v[214:215] offset:4096
    v_cvt_pk_bf16_f32 v222, v176, v177
    v_mfma_f32_16x16x32_bf16 v[156:159], a[152:155], a[212:215], v[156:159]
    v_cvt_pk_bf16_f32 v223, v178, v179
    ds_write_b64 v96, v[222:223] offset:4608
    v_cvt_pk_bf16_f32 v228, v180, v181
    v_cvt_pk_bf16_f32 v229, v182, v183
    ds_write_b64 v96, v[228:229] offset:5120
    v_cvt_pk_bf16_f32 v234, v188, v189
    v_cvt_pk_bf16_f32 v235, v190, v191
    ds_write_b64 v96, v[234:235] offset:5632
    buffer_load_dwordx4 v2, s[32:35], s47 offen offset:1024 sc1 lds
    v_cvt_pk_bf16_f32 v208, v152, v153
    v_cvt_pk_bf16_f32 v209, v154, v155
    v_cvt_pk_bf16_f32 v112, v168, v169
    v_cvt_pk_bf16_f32 v113, v170, v171
    v_cvt_pk_bf16_f32 v118, v172, v173
    v_cvt_pk_bf16_f32 v119, v174, v175
    v_cvt_pk_bf16_f32 v206, v128, v129
    v_cvt_pk_bf16_f32 v207, v130, v131
    v_cvt_pk_bf16_f32 v210, v132, v133
    v_cvt_pk_bf16_f32 v211, v134, v135
    s_waitcnt lgkmcnt(0)
    s_barrier
    ds_read_b64 v[200:201], v96 offset:0
    ds_read_b64 v[204:205], v96 offset:512
    ds_read_b64 v[202:203], v96 offset:1024
    ds_read_b64 v[218:219], v96 offset:1536
    ds_read_b64 v[224:225], v96 offset:2048
    ds_read_b64 v[230:231], v96 offset:2560
    v_permlane32_swap_b32 v214, v116
    v_permlane32_swap_b32 v215, v117
    v_permlane32_swap_b32 v208, v108
    v_permlane32_swap_b32 v209, v109
    v_and_b32 v114, v98, v116
    v_and_b32 v115, v98, v117
    v_and_b32 v116, v99, v116
    v_and_b32 v117, v99, v117
    s_add_u32 m0, s65, 24576
    s_add_u32 s47, s69, 49152
    buffer_load_dwordx4 v2, s[32:35], s47 offen sc1 lds
    buffer_load_dwordx4 v2, s[32:35], s47 offen offset:1024 sc1 lds
    v_mfma_f32_16x16x32_bf16 v[164:167], v[212:215], v[112:115], v[86:89]
    v_cvt_pk_bf16_f32 v104, v136, v137
    v_cvt_pk_bf16_f32 v105, v138, v139
    v_mfma_f32_16x16x32_bf16 v[160:163], v[206:209], v[112:115], v[90:93]
    v_cvt_pk_bf16_f32 v110, v140, v141
    v_cvt_pk_bf16_f32 v111, v142, v143
    v_mfma_f32_16x16x32_bf16 v[172:175], v[214:217], v[116:119], v[86:89]
    v_mfma_f32_16x16x32_bf16 v[168:171], v[208:211], v[116:119], v[90:93]
    v_and_b32 v106, v98, v108
    v_and_b32 v107, v98, v109
    v_and_b32 v108, v99, v108
    v_and_b32 v109, v99, v109
    s_waitcnt lgkmcnt(0)
    v_mfma_f32_16x16x32_bf16 v[132:135], v[206:209], v[104:107], v[86:89]
    v_max3_f32 v176, v164, v165, v160
    v_max3_f32 v177, v166, v167, v162
    v_mfma_f32_16x16x32_bf16 v[128:131], v[200:203], v[104:107], v[124:127]
    v_max_f32 v176, v176, v161
    v_max_f32 v177, v177, v163
    v_mfma_f32_16x16x32_bf16 v[140:143], v[208:211], v[108:111], v[86:89]
    v_max3_f32 v180, v172, v173, v168
    v_max3_f32 v181, v174, v175, v170
    v_mfma_f32_16x16x32_bf16 v[136:139], v[202:205], v[108:111], v[124:127]
    v_max_f32 v180, v180, v169
    v_max_f32 v181, v181, v171
    s_add_u32 m0, s65, 32768
    s_add_u32 s47, s69, 57344
    buffer_load_dwordx4 v2, s[32:35], s47 offen sc1 lds
    buffer_load_dwordx4 v2, s[32:35], s47 offen offset:1024 sc1 lds
    v_max_f32 v178, v176, v177
    v_max_f32 v182, v180, v181
    v_max3_f32 v184, v132, v133, v128
    v_max3_f32 v185, v134, v135, v130
    v_max_f32 v184, v184, v129
    v_max_f32 v185, v185, v131
    v_permlane32_swap_b32 v178, v182
    v_max3_f32 v188, v140, v141, v136
    v_max3_f32 v189, v142, v143, v138
    v_max_f32 v188, v188, v137
    v_max_f32 v189, v189, v139
    v_max_f32 v186, v184, v185
    v_max_f32 v190, v188, v189
    v_max_f32 v178, v178, v182
    v_cvt_pk_bf16_f32 v220, v144, v145
    v_permlane32_swap_b32 v186, v190
    v_max_f32 v186, v186, v190
    v_cvt_pk_bf16_f32 v221, v146, v147
    v_cvt_pk_bf16_f32 v226, v148, v149
    v_permlane16_swap_b32 v178, v186
    v_max_f32 v178, v178, v186
    v_mul_f32 v186, s84, v178
    v_mul_f32 v178, s84, v178
    v_cvt_pk_bf16_f32 v227, v150, v151
    v_cvt_pk_bf16_f32 v232, v156, v157
    v_permlane16_swap_b32 v178, v186
    v_mov_b32 v182, v178
    v_mov_b32 v190, v186
    v_cvt_pk_bf16_f32 v233, v158, v159
    v_permlane32_swap_b32 v178, v182
    v_permlane32_swap_b32 v186, v190
    s_add_u32 m0, s65, 40960
    s_add_u32 s47, s69, 65536
    buffer_load_dwordx4 v2, s[32:35], s47 offen sc1 lds
    buffer_load_dwordx4 v2, s[32:35], s47 offen offset:1024 sc1 lds
    v_fma_f32 v176, v176, s84, -v178
    v_fma_f32 v177, v177, s84, -v178
    v_fma_f32 v180, v180, s84, -v182
    v_fma_f32 v181, v181, s84, -v182
    v_fma_f32 v184, v184, s84, -v186
    v_fma_f32 v185, v185, s84, -v186
    v_fma_f32 v188, v188, s84, -v190
    v_fma_f32 v189, v189, s84, -v190
    v_exp_f32 v176, v176
    v_exp_f32 v177, v177
    v_exp_f32 v180, v180
    v_exp_f32 v181, v181
    v_exp_f32 v184, v184
    v_exp_f32 v185, v185
    v_exp_f32 v188, v188
    v_exp_f32 v189, v189
    s_add_u32 m0, s65, 49152
    s_add_u32 s47, s69, 73728
    buffer_load_dwordx4 v2, s[32:35], s47 offen sc1 lds
    buffer_load_dwordx4 v2, s[32:35], s47 offen offset:1024 sc1 lds
    v_cvt_pk_bf16_f32 v176, v176, v177
    v_perm_b32 v40, v176, v176, v94
    v_perm_b32 v41, v176, v176, v95
    v_perm_b32 v42, v176, v176, v237
    v_perm_b32 v43, v176, v176, v238
    v_cvt_pk_bf16_f32 v180, v180, v181
    v_perm_b32 v44, v180, v180, v94
    v_mfma_f32_16x16x32_bf16 v[176:179], a[160:163], v[40:43], 0
    v_perm_b32 v45, v180, v180, v95
    v_perm_b32 v46, v180, v180, v237
    v_mfma_f32_16x16x32_bf16 v[160:163], v[220:223], v[40:43], 0
    v_perm_b32 v47, v180, v180, v238
    v_mfma_f32_16x16x32_bf16 v[164:167], v[232:235], v[40:43], 0
    v_cvt_pk_bf16_f32 v184, v184, v185
    v_perm_b32 v48, v184, v184, v94
    v_mfma_f32_16x16x32_bf16 v[180:183], a[160:163], v[44:47], 0
    v_perm_b32 v49, v184, v184, v95
    v_perm_b32 v50, v184, v184, v237
    v_mfma_f32_16x16x32_bf16 v[168:171], v[226:229], v[44:47], 0
    v_perm_b32 v51, v184, v184, v238
    v_mfma_f32_16x16x32_bf16 v[172:175], v[232:235], v[44:47], 0
    v_cvt_pk_bf16_f32 v188, v188, v189
    v_perm_b32 v52, v188, v188, v94
    v_mfma_f32_16x16x32_bf16 v[184:187], a[160:163], v[48:51], 0
    v_perm_b32 v53, v188, v188, v95
    v_perm_b32 v54, v188, v188, v237
    v_mfma_f32_16x16x32_bf16 v[128:131], v[218:221], v[48:51], 0
    v_perm_b32 v55, v188, v188, v238
    v_mfma_f32_16x16x32_bf16 v[132:135], v[230:233], v[48:51], 0
    s_nop 0
    v_mfma_f32_16x16x32_bf16 v[188:191], a[160:163], v[52:55], 0
    v_rcp_f32 v176, v176
    v_mfma_f32_16x16x32_bf16 v[136:139], v[224:227], v[52:55], 0
    v_rcp_f32 v180, v180
    v_mfma_f32_16x16x32_bf16 v[140:143], v[230:233], v[52:55], 0
    v_pk_mul_f32 v[160:161], v[160:161], v[176:177] op_sel_hi:[1,0]
    v_pk_mul_f32 v[162:163], v[162:163], v[176:177] op_sel_hi:[1,0]
    v_pk_mul_f32 v[168:169], v[168:169], v[180:181] op_sel_hi:[1,0]
    v_pk_mul_f32 v[170:171], v[170:171], v[180:181] op_sel_hi:[1,0]
    v_cvt_pk_bf16_f32 v104, v160, v161
    v_cvt_pk_bf16_f32 v105, v162, v163
    v_cvt_pk_bf16_f32 v106, v168, v169
    v_cvt_pk_bf16_f32 v107, v170, v171
    buffer_store_dwordx4 v[104:107], v2, s[32:35], s23 offen sc1
    v_pk_mul_f32 v[172:173], v[172:173], v[180:181] op_sel_hi:[1,0]
    v_pk_mul_f32 v[174:175], v[174:175], v[180:181] op_sel_hi:[1,0]
    v_pk_mul_f32 v[164:165], v[164:165], v[176:177] op_sel_hi:[1,0]
    v_pk_mul_f32 v[166:167], v[166:167], v[176:177] op_sel_hi:[1,0]
    v_cvt_pk_bf16_f32 v112, v172, v173
    v_cvt_pk_bf16_f32 v113, v174, v175
    v_cvt_pk_bf16_f32 v108, v164, v165
    v_cvt_pk_bf16_f32 v109, v166, v167
    v_permlane16_swap_b32 v112, v110
    v_permlane16_swap_b32 v113, v111
    buffer_store_dwordx4 v[108:111], v102, s[32:35], s25 offen sc1
    v_rcp_f32 v184, v184
    v_rcp_f32 v188, v188
    v_pk_mul_f32 v[128:129], v[128:129], v[184:185] op_sel_hi:[1,0]
    v_pk_mul_f32 v[130:131], v[130:131], v[184:185] op_sel_hi:[1,0]
    v_pk_mul_f32 v[136:137], v[136:137], v[188:189] op_sel_hi:[1,0]
    v_pk_mul_f32 v[138:139], v[138:139], v[188:189] op_sel_hi:[1,0]
    v_cvt_pk_bf16_f32 v200, v128, v129
    v_cvt_pk_bf16_f32 v201, v130, v131
    v_cvt_pk_bf16_f32 v202, v136, v137
    v_cvt_pk_bf16_f32 v203, v138, v139
    buffer_store_dwordx4 v[200:203], v2, s[32:35], s22 offen sc1
    v_pk_mul_f32 v[140:141], v[140:141], v[188:189] op_sel_hi:[1,0]
    v_pk_mul_f32 v[142:143], v[142:143], v[188:189] op_sel_hi:[1,0]
    v_pk_mul_f32 v[132:133], v[132:133], v[184:185] op_sel_hi:[1,0]
    v_pk_mul_f32 v[134:135], v[134:135], v[184:185] op_sel_hi:[1,0]
    v_cvt_pk_bf16_f32 v208, v140, v141
    v_cvt_pk_bf16_f32 v209, v142, v143
    v_cvt_pk_bf16_f32 v204, v132, v133
    v_cvt_pk_bf16_f32 v205, v134, v135
    v_permlane16_swap_b32 v208, v206
    v_permlane16_swap_b32 v209, v207
    buffer_store_dwordx4 v[204:207], v102, s[32:35], s24 offen sc1
    s_add_u32 m0, s65, 57344
    s_add_u32 s47, s69, 81920
    buffer_load_dwordx4 v2, s[32:35], s47 offen sc1 lds
    buffer_load_dwordx4 v2, s[32:35], s47 offen offset:1024 sc1 lds
    s_add_u32 m0, s65, 65536
    s_add_u32 s47, s69, 90112
    buffer_load_dwordx4 v2, s[32:35], s47 offen sc1 lds
    buffer_load_dwordx4 v2, s[32:35], s47 offen offset:1024 sc1 lds
    s_add_u32 m0, s65, 73728
    s_add_u32 s47, s69, 98304
    buffer_load_dwordx4 v9, s[32:35], s47 offen sc1 lds
    buffer_load_dwordx4 v9, s[32:35], s47 offen offset:1024 sc1 lds
    s_and_b32 s76, s73, 7
    s_mul_i32 s79, s76, 49152
    s_add_u32 s79, s79, s45
    s_lshr_b32 s76, s76, 1
    v_lshl_add_u32 v243, v6, 2, s76
    v_lshlrev_b32 v243, 7, v243
    s_waitcnt vmcnt(31)
    v_lshl_add_u32 v27, v6, 2, v5
    v_lshlrev_b32 v27, 2, v27
    ds_bpermute_b32 v12, v27, v12
    ds_bpermute_b32 v13, v27, v13
    ds_bpermute_b32 v14, v27, v14
    ds_bpermute_b32 v15, v27, v15
    ds_bpermute_b32 v16, v27, v16
    ds_bpermute_b32 v17, v27, v17
    ds_bpermute_b32 v18, v27, v18
    ds_bpermute_b32 v19, v27, v19
    ds_bpermute_b32 v20, v27, v20
    ds_bpermute_b32 v21, v27, v21
    v_mov_b32 v26, 160384
    v_lshl_add_u32 v24, v5, 5, v26
    v_and_b32 v25, 1, v5
    v_lshl_add_u32 v25, v25, 5, v26
    v_lshrrev_b32 v26, 1, v5
    v_lshl_add_u32 v25, v26, 4, v25
    ds_read_b128 v[64:67], v24 offset:0
    ds_read_b128 v[68:71], v24 offset:16
    ds_read_b128 v[72:75], v24 offset:128
    ds_read_b128 v[76:79], v24 offset:144
    ds_read_b128 v[80:83], v25 offset:256
    s_and_b32 s77, s74, 4
    s_add_u32 s77, s77, s74
    s_lshl_b32 s77, s77, 11
    s_add_u32 s80, s77, s79
    s_add_u32 s80, s80, 786432
    s_lshl_b32 s77, s74, 9
    s_add_u32 s81, s77, s79
    s_add_u32 s81, s81, 819200
    s_lshl_b32 s77, s74, 7
    s_add_u32 s82, s77, s79
    s_add_u32 s82, s82, 823296
    s_waitcnt vmcnt(6)
    s_add_u32 s67, s46, 65536
    buffer_store_dword v22, v60, s[32:35], s67 offen sc1
    v_subrev_u32 v39, s64, v39
    v_subrev_u32 v39, 1, v39
    v_cmp_lt_u32 vcc, 7, v39
    s_nop 0
    s_cbranch_vccz L_probed_23
    s_mov_b32 s67, 0
L_poll_24:
    s_mov_b32 s76, 360448
    buffer_load_dword v39, v11, s[32:35], s76 offen sc1
    s_waitcnt vmcnt(0)
    v_subrev_u32 v39, s64, v39
    v_subrev_u32 v39, 1, v39
    v_cmp_lt_u32 vcc, 7, v39
    s_nop 0
    s_cbranch_vccz L_ready_25
    s_add_u32 s67, s67, 1
    s_cmp_lt_u32 s67, 20000
    s_cbranch_scc1 L_poll_24
L_ready_25:
L_probed_23:
    v_and_b32 v49, 31, v1
    s_and_b32 s76, s60, 1
    s_mul_i32 s76, s76, s74
    s_cmp_ge_u32 s76, 6
    s_cselect_b32 s76, 19, 27
    v_min_u32 v49, s76, v49
    s_mul_i32 s76, s60, 448
    v_lshl_add_u32 v49, v49, 4, s76
    v_lshrrev_b32 v48, 5, v1
    v_mul_u32_u24 v48, 3584, v48
    v_add_u32 v48, v48, v49
    v_add_u32 v49, 161792, v49
    s_mul_i32 s83, s62, 7168
    s_add_u32 s83, s83, 1441792
    v_cmp_gt_u32 vcc, 32, v1
    v_lshlrev_b32 v33, 3, v1
    s_waitcnt lgkmcnt(5)
    v_cndmask_b32 v32, v61, v2, vcc
    v_cmp_gt_u32 vcc, 16, v1
    v_lshlrev_b32 v104, 16, v12
    v_and_b32 v105, 0xffff0000, v12
    v_lshlrev_b32 v106, 16, v13
    v_and_b32 v107, 0xffff0000, v13
    v_lshlrev_b32 v108, 16, v14
    v_and_b32 v109, 0xffff0000, v14
    v_lshlrev_b32 v110, 16, v15
    v_and_b32 v111, 0xffff0000, v15
    v_lshlrev_b32 v112, 16, v16
    v_and_b32 v113, 0xffff0000, v16
    v_lshlrev_b32 v114, 16, v17
    v_and_b32 v115, 0xffff0000, v17
    v_lshlrev_b32 v116, 16, v18
    v_and_b32 v117, 0xffff0000, v18
    v_lshlrev_b32 v118, 16, v19
    v_and_b32 v119, 0xffff0000, v19
    v_lshlrev_b32 v120, 16, v20
L_pad3:
    s_cbranch_execz L_pad7
    v_and_b32 v121, 0xffff0000, v20
    v_lshlrev_b32 v122, 16, v21
    v_and_b32 v123, 0xffff0000, v21
    v_cndmask_b32 v33, v61, v33, vcc
    s_add_u32 s3, s46, 65536
    buffer_load_dword v24, v243, s[32:35], s3 offen sc1
    s_waitcnt vmcnt(2)
    s_barrier
    ds_read_b128 v[148:151], v3 offset:49152
    ds_read_b128 v[152:155], v3 offset:50176
    ds_read_b128 v[156:159], v3 offset:51200
    ds_read_b128 v[160:163], v3 offset:52224
    ds_read_b128 v[164:167], v3 offset:53248
    ds_read_b128 v[168:171], v3 offset:54272
    ds_read_b128 v[172:175], v3 offset:55296
    ds_read_b128 v[176:179], v3 offset:56320
    ds_read_b128 v[180:183], v3 offset:57344
    ds_read_b128 v[184:187], v3 offset:58368
    s_waitcnt lgkmcnt(14)
    ds_read_b128 v[188:191], v3 offset:59392
    s_waitcnt lgkmcnt(14)
    ds_read_b128 v[192:195], v3 offset:60416
    s_waitcnt lgkmcnt(14)
    ds_read_b128 v[196:199], v3 offset:61440
    s_waitcnt lgkmcnt(14)
    ds_read_b128 v[200:203], v3 offset:62464
    s_waitcnt lgkmcnt(14)
    ds_read_b128 v[204:207], v3 offset:63488
    s_waitcnt lgkmcnt(14)
    ds_read_b128 v[208:211], v3 offset:64512
    s_waitcnt lgkmcnt(14)
    ds_read_b128 v[212:215], v4 offset:0
    s_waitcnt lgkmcnt(14)
    ds_read_b128 v[216:219], v4 offset:1024
    s_waitcnt lgkmcnt(14)
    ds_read_b128 v[220:223], v4 offset:2048
    s_waitcnt lgkmcnt(14)
    ds_read_b128 v[224:227], v4 offset:3072
    s_waitcnt lgkmcnt(14)
    ds_read_b128 v[228:231], v4 offset:4096
    s_waitcnt lgkmcnt(14)
    ds_read_b128 v[232:235], v4 offset:5120
    s_waitcnt lgkmcnt(14)
    ds_read_b128 v[236:239], v4 offset:6144
    s_waitcnt vmcnt(0)
    v_subrev_u32 v24, s64, v24
    v_subrev_u32 v24, 1, v24
    v_cmp_lt_u32 vcc, 7, v24
    s_nop 0
    s_cbranch_vccz L_probed_26
    s_mov_b32 s67, 0
L_poll_27:
    s_add_u32 s76, s46, 65536
    buffer_load_dword v24, v243, s[32:35], s76 offen sc1
    s_waitcnt vmcnt(0)
    v_subrev_u32 v24, s64, v24
    v_subrev_u32 v24, 1, v24
    v_cmp_lt_u32 vcc, 7, v24
    s_nop 0
    s_cbranch_vccz L_ready_28
    s_add_u32 s67, s67, 1
    s_cmp_lt_u32 s67, 20000
    s_cbranch_scc1 L_poll_27
L_ready_28:
L_probed_26:
    s_add_u32 s78, s79, 393216
    buffer_load_dwordx4 a[0:3], v2, s[32:35], s78 offen offset:0 sc1
    buffer_load_dwordx4 a[4:7], v2, s[32:35], s78 offen offset:1024 sc1
    buffer_load_dwordx4 a[8:11], v2, s[32:35], s78 offen offset:2048 sc1
    buffer_load_dwordx4 a[12:15], v2, s[32:35], s78 offen offset:3072 sc1
    s_add_u32 s78, s79, 397312
    buffer_load_dwordx4 a[16:19], v2, s[32:35], s78 offen offset:0 sc1
    buffer_load_dwordx4 a[20:23], v2, s[32:35], s78 offen offset:1024 sc1
    buffer_load_dwordx4 a[24:27], v2, s[32:35], s78 offen offset:2048 sc1
    buffer_load_dwordx4 a[28:31], v2, s[32:35], s78 offen offset:3072 sc1
    s_add_u32 s78, s79, 409600
    buffer_load_dwordx4 a[32:35], v2, s[32:35], s78 offen offset:0 sc1
    buffer_load_dwordx4 a[36:39], v2, s[32:35], s78 offen offset:1024 sc1
    s_waitcnt vmcnt(9)
    v_mfma_f32_16x16x32_bf16 v[128:131], v[148:151], a[0:3], 0
    buffer_load_dwordx4 a[40:43], v2, s[32:35], s78 offen offset:2048 sc1
    v_mfma_f32_16x16x32_bf16 v[132:135], v[152:155], a[0:3], 0
    s_waitcnt lgkmcnt(14)
    v_mfma_f32_16x16x32_bf16 v[136:139], v[156:159], a[0:3], 0
    s_waitcnt lgkmcnt(13)
    v_mfma_f32_16x16x32_bf16 v[140:143], v[160:163], a[0:3], 0
    v_mfma_f32_16x16x32_bf16 v[144:147], v[164:167], a[0:3], 0
    s_waitcnt vmcnt(9) lgkmcnt(11)
    buffer_load_dwordx4 a[44:47], v2, s[32:35], s78 offen offset:3072 sc1
    v_mfma_f32_16x16x32_bf16 v[128:131], v[168:171], a[4:7], v[128:131]
    v_mfma_f32_16x16x32_bf16 v[132:135], v[172:175], a[4:7], v[132:135]
    s_add_u32 s78, s79, 413696
    v_mfma_f32_16x16x32_bf16 v[136:139], v[176:179], a[4:7], v[136:139]
    v_mfma_f32_16x16x32_bf16 v[140:143], v[180:183], a[4:7], v[140:143]
    buffer_load_dwordx4 a[48:51], v2, s[32:35], s78 offen offset:0 sc1
    v_mfma_f32_16x16x32_bf16 v[144:147], v[184:187], a[4:7], v[144:147]
    s_waitcnt vmcnt(10) lgkmcnt(6)
    v_mfma_f32_16x16x32_bf16 v[128:131], v[188:191], a[8:11], v[128:131]
    ds_read_b128 v[148:151], v4 offset:7168
    v_mfma_f32_16x16x32_bf16 v[132:135], v[192:195], a[8:11], v[132:135]
    ds_read_b128 v[152:155], v2 offset:0
    v_mfma_f32_16x16x32_bf16 v[136:139], v[196:199], a[8:11], v[136:139]
    ds_read_b128 v[156:159], v2 offset:1024
    v_mfma_f32_16x16x32_bf16 v[140:143], v[200:203], a[8:11], v[140:143]
    buffer_load_dwordx4 a[52:55], v2, s[32:35], s78 offen offset:1024 sc1
    v_mfma_f32_16x16x32_bf16 v[144:147], v[204:207], a[8:11], v[144:147]
    s_waitcnt vmcnt(10) lgkmcnt(4)
    ds_read_b128 v[160:163], v2 offset:2048
    v_mfma_f32_16x16x32_bf16 v[128:131], v[208:211], a[12:15], v[128:131]
    ds_read_b128 v[164:167], v2 offset:3072
    v_mfma_f32_16x16x32_bf16 v[132:135], v[212:215], a[12:15], v[132:135]
    ds_read_b128 v[168:171], v2 offset:4096
    v_mfma_f32_16x16x32_bf16 v[136:139], v[216:219], a[12:15], v[136:139]
    buffer_load_dwordx4 a[56:59], v2, s[32:35], s78 offen offset:2048 sc1
    v_mfma_f32_16x16x32_bf16 v[140:143], v[220:223], a[12:15], v[140:143]
    ds_read_b128 v[172:175], v2 offset:5120
    v_mfma_f32_16x16x32_bf16 v[144:147], v[224:227], a[12:15], v[144:147]
    s_waitcnt vmcnt(10) lgkmcnt(4)
    ds_read_b128 v[176:179], v2 offset:6144
    v_mfma_f32_16x16x32_bf16 v[128:131], v[228:231], a[16:19], v[128:131]
    ds_read_b128 v[180:183], v2 offset:7168
    v_mfma_f32_16x16x32_bf16 v[132:135], v[232:235], a[16:19], v[132:135]
    ds_read_b128 v[184:187], v2 offset:8192
    v_mfma_f32_16x16x32_bf16 v[136:139], v[236:239], a[16:19], v[136:139]
    buffer_load_dwordx4 a[60:63], v2, s[32:35], s78 offen offset:3072 sc1
    v_mfma_f32_16x16x32_bf16 v[140:143], v[148:151], a[16:19], v[140:143]
    ds_read_b128 v[188:191], v2 offset:9216
    ds_read_b128 v[192:195], v2 offset:10240
    v_mfma_f32_16x16x32_bf16 v[144:147], v[152:155], a[16:19], v[144:147]
    s_waitcnt vmcnt(10) lgkmcnt(5)
    ds_read_b128 v[196:199], v2 offset:11264
    v_mfma_f32_16x16x32_bf16 v[128:131], v[156:159], a[20:23], v[128:131]
    s_add_u32 s78, s79, 425984
    ds_read_b128 v[200:203], v2 offset:12288
    v_mfma_f32_16x16x32_bf16 v[132:135], v[160:163], a[20:23], v[132:135]
    buffer_load_dwordx4 a[64:67], v2, s[32:35], s78 offen offset:0 sc1
    v_mfma_f32_16x16x32_bf16 v[136:139], v[164:167], a[20:23], v[136:139]
    ds_read_b128 v[204:207], v2 offset:13312
    ds_read_b128 v[208:211], v2 offset:14336
    v_mfma_f32_16x16x32_bf16 v[140:143], v[168:171], a[20:23], v[140:143]
    ds_read_b128 v[212:215], v2 offset:15360
    v_mfma_f32_16x16x32_bf16 v[144:147], v[172:175], a[20:23], v[144:147]
    s_waitcnt vmcnt(10) lgkmcnt(5)
    ds_read_b128 v[216:219], v2 offset:16384
    v_mfma_f32_16x16x32_bf16 v[128:131], v[176:179], a[24:27], v[128:131]
    ds_read_b128 v[220:223], v2 offset:17408
    v_mfma_f32_16x16x32_bf16 v[132:135], v[180:183], a[24:27], v[132:135]
    buffer_load_dwordx4 a[68:71], v2, s[32:35], s78 offen offset:1024 sc1
    v_mfma_f32_16x16x32_bf16 v[136:139], v[184:187], a[24:27], v[136:139]
    ds_read_b128 v[224:227], v2 offset:18432
    ds_read_b128 v[228:231], v2 offset:19456
    v_mfma_f32_16x16x32_bf16 v[140:143], v[188:191], a[24:27], v[140:143]
    ds_read_b128 v[232:235], v2 offset:20480
    v_mfma_f32_16x16x32_bf16 v[144:147], v[192:195], a[24:27], v[144:147]
    s_waitcnt vmcnt(10) lgkmcnt(5)
    ds_read_b128 v[236:239], v2 offset:21504
    v_mfma_f32_16x16x32_bf16 v[128:131], v[196:199], a[28:31], v[128:131]
    buffer_load_dwordx4 a[72:75], v2, s[32:35], s78 offen offset:2048 sc1
    v_mfma_f32_16x16x32_bf16 v[132:135], v[200:203], a[28:31], v[132:135]
    ds_read_b128 v[148:151], v2 offset:22528
    ds_read_b128 v[152:155], v2 offset:23552
    v_mfma_f32_16x16x32_bf16 v[136:139], v[204:207], a[28:31], v[136:139]
    ds_read_b128 v[156:159], v2 offset:24576
    v_mfma_f32_16x16x32_bf16 v[140:143], v[208:211], a[28:31], v[140:143]
    ds_read_b128 v[160:163], v2 offset:25600
    v_mfma_f32_16x16x32_bf16 v[144:147], v[212:215], a[28:31], v[144:147]
    s_waitcnt vmcnt(10) lgkmcnt(5)
    ds_read_b128 v[164:167], v2 offset:26624
    v_mfma_f32_16x16x32_bf16 v[128:131], v[216:219], a[32:35], v[128:131]
    buffer_load_dwordx4 a[76:79], v2, s[32:35], s78 offen offset:3072 sc1
    v_mfma_f32_16x16x32_bf16 v[132:135], v[220:223], a[32:35], v[132:135]
    ds_read_b128 v[168:171], v2 offset:27648
    ds_read_b128 v[172:175], v2 offset:28672
    v_mfma_f32_16x16x32_bf16 v[136:139], v[224:227], a[32:35], v[136:139]
    ds_read_b128 v[176:179], v2 offset:29696
    v_mfma_f32_16x16x32_bf16 v[140:143], v[228:231], a[32:35], v[140:143]
    ds_read_b128 v[180:183], v2 offset:30720
    v_mfma_f32_16x16x32_bf16 v[144:147], v[232:235], a[32:35], v[144:147]
    s_waitcnt vmcnt(10) lgkmcnt(5)
    buffer_load_dwordx4 v[40:43], v48, s[32:35], s83 offen offset:0 sc1
    v_mfma_f32_16x16x32_bf16 v[128:131], v[236:239], a[36:39], v[128:131]
    ds_read_b128 v[184:187], v2 offset:31744
    ds_read_b128 v[188:191], v2 offset:32768
    v_mfma_f32_16x16x32_bf16 v[132:135], v[148:151], a[36:39], v[132:135]
    ds_read_b128 v[192:195], v2 offset:33792
    v_mfma_f32_16x16x32_bf16 v[136:139], v[152:155], a[36:39], v[136:139]
    ds_read_b128 v[196:199], v2 offset:34816
    v_mfma_f32_16x16x32_bf16 v[140:143], v[156:159], a[36:39], v[140:143]
    ds_read_b128 v[200:203], v2 offset:35840
    v_mfma_f32_16x16x32_bf16 v[144:147], v[160:163], a[36:39], v[144:147]
    s_waitcnt vmcnt(10) lgkmcnt(5)
    buffer_load_dwordx4 v[44:47], v48, s[32:35], s83 offen offset:1792 sc1
    v_mfma_f32_16x16x32_bf16 v[128:131], v[164:167], a[40:43], v[128:131]
    ds_read_b128 v[204:207], v2 offset:36864
    ds_read_b128 v[208:211], v2 offset:37888
    v_mfma_f32_16x16x32_bf16 v[132:135], v[168:171], a[40:43], v[132:135]
    s_add_u32 m0, s65, 139264
    ds_read_b128 v[212:215], v2 offset:38912
    v_mfma_f32_16x16x32_bf16 v[136:139], v[172:175], a[40:43], v[136:139]
    s_add_u32 s47, s70, 0
    ds_read_b128 v[216:219], v2 offset:39936
    v_mfma_f32_16x16x32_bf16 v[140:143], v[176:179], a[40:43], v[140:143]
    buffer_load_dwordx4 v2, s[32:35], s47 offen sc1 lds
    v_mfma_f32_16x16x32_bf16 v[144:147], v[180:183], a[40:43], v[144:147]
    s_waitcnt vmcnt(11) lgkmcnt(4)
    ds_read_b128 v[220:223], v2 offset:40960
    ds_read_b128 v[224:227], v2 offset:41984
    v_mfma_f32_16x16x32_bf16 v[128:131], v[184:187], a[44:47], v[128:131]
    ds_read_b128 v[228:231], v2 offset:43008
    v_mfma_f32_16x16x32_bf16 v[132:135], v[188:191], a[44:47], v[132:135]
    ds_read_b128 v[232:235], v2 offset:44032
    v_mfma_f32_16x16x32_bf16 v[136:139], v[192:195], a[44:47], v[136:139]
    ds_read_b128 v[236:239], v2 offset:45056
    v_mfma_f32_16x16x32_bf16 v[140:143], v[196:199], a[44:47], v[140:143]
    buffer_load_dwordx4 v2, s[32:35], s47 offen offset:1024 sc1 lds
    v_mfma_f32_16x16x32_bf16 v[144:147], v[200:203], a[44:47], v[144:147]
    s_waitcnt vmcnt(11) lgkmcnt(5)
    ds_read_b128 v[148:151], v2 offset:46080
    ds_read_b128 v[152:155], v2 offset:47104
    v_mfma_f32_16x16x32_bf16 v[128:131], v[204:207], a[48:51], v[128:131]
    s_add_u32 m0, s65, 147456
    ds_read_b128 v[156:159], v2 offset:48128
    v_mfma_f32_16x16x32_bf16 v[132:135], v[208:211], a[48:51], v[132:135]
    s_add_u32 s47, s70, 8192
    ds_read_b128 v[160:163], v2 offset:49152
    v_mfma_f32_16x16x32_bf16 v[136:139], v[212:215], a[48:51], v[136:139]
    buffer_load_dwordx4 v2, s[32:35], s47 offen sc1 lds
    v_mfma_f32_16x16x32_bf16 v[140:143], v[216:219], a[48:51], v[140:143]
    s_waitcnt lgkmcnt(4)
    ds_read_b128 v[164:167], v2 offset:50176
    ds_read_b128 v[168:171], v2 offset:51200
    v_mfma_f32_16x16x32_bf16 v[144:147], v[220:223], a[48:51], v[144:147]
    s_waitcnt vmcnt(11)
    ds_read_b128 v[172:175], v2 offset:52224
    v_mfma_f32_16x16x32_bf16 v[128:131], v[224:227], a[52:55], v[128:131]
    ds_read_b128 v[176:179], v2 offset:53248
    v_mfma_f32_16x16x32_bf16 v[132:135], v[228:231], a[52:55], v[132:135]
    ds_read_b128 v[180:183], v2 offset:54272
    v_mfma_f32_16x16x32_bf16 v[136:139], v[232:235], a[52:55], v[136:139]
    buffer_load_dwordx4 v2, s[32:35], s47 offen offset:1024 sc1 lds
    v_mfma_f32_16x16x32_bf16 v[140:143], v[236:239], a[52:55], v[140:143]
    s_waitcnt lgkmcnt(5)
    ds_read_b128 v[184:187], v2 offset:55296
    ds_read_b128 v[188:191], v2 offset:56320
    v_mfma_f32_16x16x32_bf16 v[144:147], v[148:151], a[52:55], v[144:147]
    s_waitcnt vmcnt(11) lgkmcnt(5)
    ds_read_b128 v[192:195], v2 offset:57344
    v_mfma_f32_16x16x32_bf16 v[128:131], v[152:155], a[56:59], v[128:131]
    s_add_u32 m0, s65, 81920
    ds_read_b128 v[196:199], v2 offset:58368
    v_mfma_f32_16x16x32_bf16 v[132:135], v[156:159], a[56:59], v[132:135]
    s_add_u32 s47, s70, 16384
    ds_read_b128 v[200:203], v2 offset:59392
    v_mfma_f32_16x16x32_bf16 v[136:139], v[160:163], a[56:59], v[136:139]
    buffer_load_dwordx4 v2, s[32:35], s47 offen sc1 lds
    v_mfma_f32_16x16x32_bf16 v[140:143], v[164:167], a[56:59], v[140:143]
    ds_read_b128 v[204:207], v2 offset:60416
    ds_read_b128 v[208:211], v2 offset:61440
    v_mfma_f32_16x16x32_bf16 v[144:147], v[168:171], a[56:59], v[144:147]
    s_waitcnt vmcnt(11) lgkmcnt(5)
    ds_read_b128 v[212:215], v2 offset:62464
    v_mfma_f32_16x16x32_bf16 v[128:131], v[172:175], a[60:63], v[128:131]
    ds_read_b128 v[216:219], v2 offset:63488
    v_mfma_f32_16x16x32_bf16 v[132:135], v[176:179], a[60:63], v[132:135]
    buffer_load_dwordx4 v2, s[32:35], s47 offen offset:1024 sc1 lds
    v_mfma_f32_16x16x32_bf16 v[136:139], v[180:183], a[60:63], v[136:139]
    ds_read_b128 v[220:223], v2 offset:64512
    ds_read_b128 v[224:227], v3 offset:0
    v_mfma_f32_16x16x32_bf16 v[140:143], v[184:187], a[60:63], v[140:143]
    s_add_u32 m0, s65, 90112
    ds_read_b128 v[228:231], v3 offset:1024
    v_mfma_f32_16x16x32_bf16 v[144:147], v[188:191], a[60:63], v[144:147]
    s_waitcnt vmcnt(11) lgkmcnt(5)
    ds_read_b128 v[232:235], v3 offset:2048
    v_mfma_f32_16x16x32_bf16 v[128:131], v[192:195], a[64:67], v[128:131]
    s_add_u32 s47, s70, 24576
    ds_read_b128 v[236:239], v3 offset:3072
    v_mfma_f32_16x16x32_bf16 v[132:135], v[196:199], a[64:67], v[132:135]
    buffer_load_dwordx4 v2, s[32:35], s47 offen sc1 lds
    v_mfma_f32_16x16x32_bf16 v[136:139], v[200:203], a[64:67], v[136:139]
    ds_read_b128 v[148:151], v3 offset:4096
    ds_read_b128 v[152:155], v3 offset:5120
    v_mfma_f32_16x16x32_bf16 v[140:143], v[204:207], a[64:67], v[140:143]
    ds_read_b128 v[156:159], v3 offset:6144
    v_mfma_f32_16x16x32_bf16 v[144:147], v[208:211], a[64:67], v[144:147]
    s_waitcnt vmcnt(11) lgkmcnt(5)
    ds_read_b128 v[160:163], v3 offset:7168
    v_mfma_f32_16x16x32_bf16 v[128:131], v[212:215], a[68:71], v[128:131]
    buffer_load_dwordx4 v2, s[32:35], s47 offen offset:1024 sc1 lds
    v_mfma_f32_16x16x32_bf16 v[132:135], v[216:219], a[68:71], v[132:135]
    ds_read_b128 v[164:167], v3 offset:8192
    ds_read_b128 v[168:171], v3 offset:9216
    v_mfma_f32_16x16x32_bf16 v[136:139], v[220:223], a[68:71], v[136:139]
    s_add_u32 m0, s65, 98304
    ds_read_b128 v[172:175], v3 offset:10240
    v_mfma_f32_16x16x32_bf16 v[140:143], v[224:227], a[68:71], v[140:143]
    s_add_u32 s47, s70, 32768
    ds_read_b128 v[176:179], v3 offset:11264
    v_mfma_f32_16x16x32_bf16 v[144:147], v[228:231], a[68:71], v[144:147]
    s_waitcnt vmcnt(11) lgkmcnt(5)
    buffer_load_dwordx4 v2, s[32:35], s47 offen sc1 lds
    v_mfma_f32_16x16x32_bf16 v[128:131], v[232:235], a[72:75], v[128:131]
    v_mfma_f32_16x16x32_bf16 v[132:135], v[236:239], a[72:75], v[132:135]
    v_mfma_f32_16x16x32_bf16 v[136:139], v[148:151], a[72:75], v[136:139]
    v_mfma_f32_16x16x32_bf16 v[140:143], v[152:155], a[72:75], v[140:143]
    v_mfma_f32_16x16x32_bf16 v[144:147], v[156:159], a[72:75], v[144:147]
    s_waitcnt vmcnt(11) lgkmcnt(0)
    buffer_load_dwordx4 v2, s[32:35], s47 offen offset:1024 sc1 lds
    v_mfma_f32_16x16x32_bf16 v[128:131], v[160:163], a[76:79], v[128:131]
    v_mfma_f32_16x16x32_bf16 v[132:135], v[164:167], a[76:79], v[132:135]
    s_add_u32 m0, s65, 106496
    s_add_u32 s47, s70, 40960
    v_mfma_f32_16x16x32_bf16 v[136:139], v[168:171], a[76:79], v[136:139]
    v_mfma_f32_16x16x32_bf16 v[140:143], v[172:175], a[76:79], v[140:143]
    buffer_load_dwordx4 v2, s[32:35], s47 offen sc1 lds
    v_mfma_f32_16x16x32_bf16 v[144:147], v[176:179], a[76:79], v[144:147]
    buffer_load_dwordx4 v2, s[32:35], s47 offen offset:1024 sc1 lds
    v_pk_fma_f32 v[128:129], v[128:129], v[64:65], v[104:105]
    v_cvt_pk_bf16_f32 v12, v128, v129
    v_pk_fma_f32 v[130:131], v[130:131], v[66:67], v[106:107]
    v_cvt_pk_bf16_f32 v13, v130, v131
    v_pk_fma_f32 v[132:133], v[132:133], v[68:69], v[108:109]
    v_cvt_pk_bf16_f32 v14, v132, v133
    v_pk_fma_f32 v[134:135], v[134:135], v[70:71], v[110:111]
    v_cvt_pk_bf16_f32 v15, v134, v135
    buffer_store_dwordx4 v[12:15], v2, s[32:35], s80 offen offset:0 sc1
    v_pk_fma_f32 v[136:137], v[136:137], v[72:73], v[112:113]
    v_cvt_pk_bf16_f32 v16, v136, v137
    v_pk_fma_f32 v[138:139], v[138:139], v[74:75], v[114:115]
    v_cvt_pk_bf16_f32 v17, v138, v139
    v_pk_fma_f32 v[140:141], v[140:141], v[76:77], v[116:117]
    v_cvt_pk_bf16_f32 v18, v140, v141
    v_pk_fma_f32 v[142:143], v[142:143], v[78:79], v[118:119]
    v_cvt_pk_bf16_f32 v19, v142, v143
    buffer_store_dwordx4 v[16:19], v2, s[32:35], s80 offen offset:1024 sc1
    v_pk_fma_f32 v[144:145], v[144:145], v[80:81], v[120:121]
    v_cvt_pk_bf16_f32 v20, v144, v145
    v_pk_fma_f32 v[146:147], v[146:147], v[82:83], v[122:123]
    v_cvt_pk_bf16_f32 v21, v146, v147
    v_cvt_pk_bf16_f32 v28, v144, v145
    v_cvt_pk_bf16_f32 v29, v146, v147
    v_pk_add_f32 v[24:25], v[128:129], v[130:131]
    v_pk_mul_f32 v[26:27], v[128:129], v[128:129]
    v_pk_fma_f32 v[26:27], v[130:131], v[130:131], v[26:27]
    v_permlane32_swap_b32 v28, v30
    v_permlane32_swap_b32 v29, v31
    buffer_store_dwordx4 v[28:31], v32, s[32:35], s81 offen sc1
    v_pk_add_f32 v[24:25], v[24:25], v[132:133]
    v_pk_fma_f32 v[26:27], v[132:133], v[132:133], v[26:27]
    v_pk_add_f32 v[24:25], v[24:25], v[134:135]
    v_pk_fma_f32 v[26:27], v[134:135], v[134:135], v[26:27]
    v_pk_add_f32 v[24:25], v[24:25], v[136:137]
    v_pk_fma_f32 v[26:27], v[136:137], v[136:137], v[26:27]
    v_pk_add_f32 v[24:25], v[24:25], v[138:139]
    v_pk_fma_f32 v[26:27], v[138:139], v[138:139], v[26:27]
    v_pk_add_f32 v[24:25], v[24:25], v[140:141]
    v_pk_fma_f32 v[26:27], v[140:141], v[140:141], v[26:27]
    v_pk_add_f32 v[24:25], v[24:25], v[142:143]
    v_pk_fma_f32 v[26:27], v[142:143], v[142:143], v[26:27]
    v_pk_add_f32 v[24:25], v[24:25], v[144:145]
    v_pk_fma_f32 v[26:27], v[144:145], v[144:145], v[26:27]
    v_pk_add_f32 v[24:25], v[24:25], v[146:147]
    v_pk_fma_f32 v[26:27], v[146:147], v[146:147], v[26:27]
    v_add_f32 v24, v24, v25
    v_add_f32 v25, v26, v27
    v_mov_b32 v26, v24
    v_mov_b32 v27, v25
    s_nop 0
    v_permlane16_swap_b32 v24, v26
    v_permlane16_swap_b32 v25, v27
    v_add_f32 v24, v24, v26
    v_add_f32 v25, v25, v27
    v_mov_b32 v26, v24
    v_mov_b32 v27, v25
    s_nop 0
    v_permlane32_swap_b32 v24, v26
    v_permlane32_swap_b32 v25, v27
    v_add_f32 v24, v24, v26
    v_add_f32 v25, v25, v27
    buffer_store_dwordx2 v[24:25], v33, s[32:35], s82 offen sc1
    s_barrier
    s_waitcnt vmcnt(16)
    v_add_f32 v40, v40, v44
    v_add_f32 v41, v41, v45
    v_add_f32 v42, v42, v46
    v_add_f32 v43, v43, v47
    v_mov_b32 v44, v40
    v_mov_b32 v45, v41
    v_mov_b32 v46, v42
    v_mov_b32 v47, v43
    v_permlane32_swap_b32 v40, v44
    v_permlane32_swap_b32 v41, v45
    v_permlane32_swap_b32 v42, v46
    v_permlane32_swap_b32 v43, v47
    v_add_f32 v40, v40, v44
    v_add_f32 v41, v41, v45
    v_add_f32 v42, v42, v46
    v_add_f32 v43, v43, v47
    ds_write_b128 v49, v[40:43]
    s_lshr_b32 s76, s60, 1
    s_lshl_b32 s76, s76, 5
    s_and_b32 s77, s60, 1
    s_lshl_b32 s77, s77, 1
    s_add_u32 s76, s76, s77
    v_and_b32 v24, 7, v6
    v_lshrrev_b32 v25, 3, v6
    v_lshl_add_u32 v24, v24, 2, v25
    v_add_u32 v24, s76, v24
    v_lshlrev_b32 v23, 7, v24
    s_mul_i32 s82, s60, 229376
    s_add_u32 s82, s82, s45
    s_add_u32 s82, s82, 1179648
    v_lshlrev_b32 v25, 8, v5
    v_lshl_add_u32 v25, v6, 3, v25
    s_add_u32 s79, s48, 823296
    s_add_u32 s80, s48, 872448
    v_mov_b32 v36, 161792
    v_lshl_add_u32 v36, v5, 4, v36
    s_lshl_b32 s76, s60, 7
    s_add_u32 s76, s76, 159744
    v_lshl_add_u32 v37, v6, 2, s76
    s_waitcnt lgkmcnt(0)
    s_waitcnt vmcnt(0)
    v_add_u32 v22, 1, v22
    s_add_u32 s67, s46, 65536
    buffer_store_dword v22, v60, s[32:35], s67 offen sc1
    s_add_u32 m0, s65, 114688
    s_add_u32 s47, s70, 49152
    buffer_load_dwordx4 v2, s[32:35], s47 offen sc1 lds
    buffer_load_dwordx4 v2, s[32:35], s47 offen offset:1024 sc1 lds
    s_add_u32 m0, s65, 122880
    s_add_u32 s47, s70, 57344
    buffer_load_dwordx4 v2, s[32:35], s47 offen sc1 lds
    buffer_load_dwordx4 v2, s[32:35], s47 offen offset:1024 sc1 lds
    s_add_u32 m0, s65, 131072
    s_add_u32 s47, s70, 65536
    buffer_load_dwordx4 v2, s[32:35], s47 offen sc1 lds
    buffer_load_dwordx4 v2, s[32:35], s47 offen offset:1024 sc1 lds
    s_add_u32 m0, s65, 0
    s_add_u32 s47, s70, 73728
    buffer_load_dwordx4 v2, s[32:35], s47 offen sc1 lds
    buffer_load_dwordx4 v2, s[32:35], s47 offen offset:1024 sc1 lds
    s_add_u32 s3, s46, 65536
    buffer_load_dword v24, v23, s[32:35], s3 offen sc1
    s_barrier
    ds_read_b128 a[208:211], v4 offset:8192
    ds_read_b128 a[212:215], v4 offset:9216
    ds_read_b128 a[216:219], v4 offset:10240
    ds_read_b128 a[220:223], v4 offset:11264
    ds_read_b128 a[224:227], v4 offset:12288
    ds_read_b128 a[228:231], v4 offset:13312
    s_waitcnt vmcnt(0)
    v_subrev_u32 v24, s64, v24
    v_subrev_u32 v24, 2, v24
    v_cmp_lt_u32 vcc, 7, v24
    s_nop 0
    s_cbranch_vccz L_probed_29
    s_mov_b32 s67, 0
L_poll_30:
    s_add_u32 s76, s46, 65536
    buffer_load_dword v24, v23, s[32:35], s76 offen sc1
    s_waitcnt vmcnt(0)
    v_subrev_u32 v24, s64, v24
    v_subrev_u32 v24, 2, v24
    v_cmp_lt_u32 vcc, 7, v24
    s_nop 0
    s_cbranch_vccz L_ready_31
    s_add_u32 s67, s67, 1
    s_cmp_lt_u32 s67, 20000
    s_cbranch_scc1 L_poll_30
L_ready_31:
L_probed_29:
    s_add_u32 s78, s48, 786432
    buffer_load_dwordx4 a[0:3], v2, s[32:35], s78 offen offset:0 sc1
    buffer_load_dwordx4 a[4:7], v7, s[32:35], s78 offen offset:0 sc1
    buffer_load_dwordx4 a[8:11], v2, s[32:35], s78 offen offset:1024 sc1
    buffer_load_dwordx4 a[12:15], v7, s[32:35], s78 offen offset:1024 sc1
    buffer_load_dwordx4 a[16:19], v2, s[32:35], s78 offen offset:2048 sc1
    buffer_load_dwordx4 a[20:23], v7, s[32:35], s78 offen offset:2048 sc1
    buffer_load_dwordx4 a[24:27], v2, s[32:35], s78 offen offset:3072 sc1
    buffer_load_dwordx4 a[28:31], v7, s[32:35], s78 offen offset:3072 sc1
    s_waitcnt vmcnt(6) lgkmcnt(3)
    v_mfma_f32_16x16x32_bf16 v[128:131], a[208:211], a[0:3], 0
    s_add_u32 s78, s48, 790528
    v_mfma_f32_16x16x32_bf16 v[184:187], a[208:211], a[4:7], 0
    buffer_load_dwordx4 a[32:35], v2, s[32:35], s78 offen offset:0 sc1
    v_mfma_f32_16x16x32_bf16 v[132:135], a[212:215], a[0:3], 0
    ds_read_b128 a[232:235], v4 offset:14336
    v_mfma_f32_16x16x32_bf16 v[188:191], a[212:215], a[4:7], 0
    ds_read_b128 a[236:239], v4 offset:15360
    v_mfma_f32_16x16x32_bf16 v[136:139], a[216:219], a[0:3], 0
    v_mfma_f32_16x16x32_bf16 v[192:195], a[216:219], a[4:7], 0
    s_waitcnt lgkmcnt(2)
    buffer_load_dwordx4 a[36:39], v7, s[32:35], s78 offen offset:0 sc1
    v_mfma_f32_16x16x32_bf16 v[140:143], a[220:223], a[0:3], 0
    ds_read_b128 a[240:243], v4 offset:16384
    v_mfma_f32_16x16x32_bf16 v[196:199], a[220:223], a[4:7], 0
    ds_read_b128 a[244:247], v4 offset:17408
    v_mfma_f32_16x16x32_bf16 v[144:147], a[224:227], a[0:3], 0
    v_mfma_f32_16x16x32_bf16 v[200:203], a[224:227], a[4:7], 0
    buffer_load_dwordx2 v[244:245], v25, s[32:35], s79 offen offset:0 sc1
    v_mfma_f32_16x16x32_bf16 v[148:151], a[228:231], a[0:3], 0
    ds_read_b128 a[248:251], v4 offset:18432
    v_mfma_f32_16x16x32_bf16 v[204:207], a[228:231], a[4:7], 0
    s_waitcnt lgkmcnt(2)
    buffer_load_dwordx2 v[246:247], v25, s[32:35], s79 offen offset:128 sc1
    v_mfma_f32_16x16x32_bf16 v[152:155], a[232:235], a[0:3], 0
    ds_read_b128 a[252:255], v4 offset:19456
    v_mfma_f32_16x16x32_bf16 v[208:211], a[232:235], a[4:7], 0
    buffer_load_dwordx2 v[248:249], v25, s[32:35], s80 offen offset:0 sc1
    v_mfma_f32_16x16x32_bf16 v[156:159], a[236:239], a[0:3], 0
    ds_read_b128 a[208:211], v4 offset:20480
    v_mfma_f32_16x16x32_bf16 v[212:215], a[236:239], a[4:7], 0
    s_waitcnt vmcnt(9) lgkmcnt(2)
    buffer_load_dwordx2 v[250:251], v25, s[32:35], s80 offen offset:128 sc1
    v_mfma_f32_16x16x32_bf16 v[128:131], a[240:243], a[8:11], v[128:131]
    ds_read_b128 a[212:215], v4 offset:21504
    v_mfma_f32_16x16x32_bf16 v[184:187], a[240:243], a[12:15], v[184:187]
    buffer_load_dwordx4 a[40:43], v2, s[32:35], s78 offen offset:1024 sc1
    v_mfma_f32_16x16x32_bf16 v[132:135], a[244:247], a[8:11], v[132:135]
    ds_read_b128 a[216:219], v4 offset:22528
    v_mfma_f32_16x16x32_bf16 v[188:191], a[244:247], a[12:15], v[188:191]
    ds_read_b128 a[220:223], v4 offset:23552
    v_mfma_f32_16x16x32_bf16 v[136:139], a[248:251], a[8:11], v[136:139]
    v_mfma_f32_16x16x32_bf16 v[192:195], a[248:251], a[12:15], v[192:195]
    s_waitcnt lgkmcnt(2)
    buffer_load_dwordx4 a[44:47], v7, s[32:35], s78 offen offset:1024 sc1
    v_mfma_f32_16x16x32_bf16 v[140:143], a[252:255], a[8:11], v[140:143]
    s_barrier
    v_mfma_f32_16x16x32_bf16 v[196:199], a[252:255], a[12:15], v[196:199]
    ds_read_b128 a[224:227], v3 offset:16384
    v_mfma_f32_16x16x32_bf16 v[144:147], a[208:211], a[8:11], v[144:147]
    ds_read_b128 a[228:231], v3 offset:17408
    v_mfma_f32_16x16x32_bf16 v[200:203], a[208:211], a[12:15], v[200:203]
    buffer_load_dwordx4 a[48:51], v2, s[32:35], s78 offen offset:2048 sc1
    v_mfma_f32_16x16x32_bf16 v[148:151], a[212:215], a[8:11], v[148:151]
    ds_read_b128 a[232:235], v3 offset:18432
    v_mfma_f32_16x16x32_bf16 v[204:207], a[212:215], a[12:15], v[204:207]
    s_waitcnt lgkmcnt(3)
    ds_read_b128 a[236:239], v3 offset:19456
    v_mfma_f32_16x16x32_bf16 v[152:155], a[216:219], a[8:11], v[152:155]
    v_mfma_f32_16x16x32_bf16 v[208:211], a[216:219], a[12:15], v[208:211]
    ds_read_b128 a[240:243], v3 offset:20480
    v_mfma_f32_16x16x32_bf16 v[156:159], a[220:223], a[8:11], v[156:159]
    buffer_load_dwordx4 a[52:55], v7, s[32:35], s78 offen offset:2048 sc1
    v_mfma_f32_16x16x32_bf16 v[212:215], a[220:223], a[12:15], v[212:215]
    s_waitcnt vmcnt(12) lgkmcnt(2)
    ds_read_b128 a[244:247], v3 offset:21504
    v_mfma_f32_16x16x32_bf16 v[128:131], a[224:227], a[16:19], v[128:131]
    v_mfma_f32_16x16x32_bf16 v[184:187], a[224:227], a[20:23], v[184:187]
    ds_read_b128 a[248:251], v3 offset:22528
    v_mfma_f32_16x16x32_bf16 v[132:135], a[228:231], a[16:19], v[132:135]
    buffer_load_dwordx4 a[56:59], v2, s[32:35], s78 offen offset:3072 sc1
    v_mfma_f32_16x16x32_bf16 v[188:191], a[228:231], a[20:23], v[188:191]
    ds_read_b128 a[252:255], v3 offset:23552
    v_mfma_f32_16x16x32_bf16 v[136:139], a[232:235], a[16:19], v[136:139]
    v_mfma_f32_16x16x32_bf16 v[192:195], a[232:235], a[20:23], v[192:195]
    s_waitcnt lgkmcnt(2)
    ds_read_b128 a[208:211], v3 offset:24576
    v_mfma_f32_16x16x32_bf16 v[140:143], a[236:239], a[16:19], v[140:143]
    buffer_load_dwordx4 a[60:63], v7, s[32:35], s78 offen offset:3072 sc1
    v_mfma_f32_16x16x32_bf16 v[196:199], a[236:239], a[20:23], v[196:199]
    ds_read_b128 a[212:215], v3 offset:25600
    v_mfma_f32_16x16x32_bf16 v[144:147], a[240:243], a[16:19], v[144:147]
    s_add_u32 s78, s48, 802816
    v_mfma_f32_16x16x32_bf16 v[200:203], a[240:243], a[20:23], v[200:203]
    ds_read_b128 a[216:219], v3 offset:26624
    v_mfma_f32_16x16x32_bf16 v[148:151], a[244:247], a[16:19], v[148:151]
    buffer_load_dwordx4 a[64:67], v2, s[32:35], s78 offen offset:0 sc1
    v_mfma_f32_16x16x32_bf16 v[204:207], a[244:247], a[20:23], v[204:207]
    s_waitcnt lgkmcnt(2)
    ds_read_b128 a[220:223], v3 offset:27648
    v_mfma_f32_16x16x32_bf16 v[152:155], a[248:251], a[16:19], v[152:155]
    v_mfma_f32_16x16x32_bf16 v[208:211], a[248:251], a[20:23], v[208:211]
    ds_read_b128 a[224:227], v3 offset:28672
    v_mfma_f32_16x16x32_bf16 v[156:159], a[252:255], a[16:19], v[156:159]
    v_mfma_f32_16x16x32_bf16 v[212:215], a[252:255], a[20:23], v[212:215]
    s_waitcnt vmcnt(13) lgkmcnt(2)
    buffer_load_dwordx4 a[68:71], v7, s[32:35], s78 offen offset:0 sc1
    v_mfma_f32_16x16x32_bf16 v[128:131], a[208:211], a[24:27], v[128:131]
    ds_read_b128 a[228:231], v3 offset:29696
    v_mfma_f32_16x16x32_bf16 v[184:187], a[208:211], a[28:31], v[184:187]
    ds_read_b128 a[232:235], v3 offset:30720
    v_mfma_f32_16x16x32_bf16 v[132:135], a[212:215], a[24:27], v[132:135]
    s_waitcnt vmcnt(8)
    v_add_f32 v244, v244, v246
    v_add_f32 v245, v245, v247
L_pad4:
    s_cbranch_execz L_pad8
    v_mfma_f32_16x16x32_bf16 v[188:191], a[212:215], a[28:31], v[188:191]
    buffer_load_dwordx4 a[72:75], v2, s[32:35], s78 offen offset:1024 sc1
    v_mfma_f32_16x16x32_bf16 v[136:139], a[216:219], a[24:27], v[136:139]
    ds_read_b128 a[236:239], v3 offset:31744
    v_add_f32 v248, v248, v250
    v_mfma_f32_16x16x32_bf16 v[192:195], a[216:219], a[28:31], v[192:195]
    s_waitcnt lgkmcnt(2)
    v_add_f32 v249, v249, v251
    v_mov_b32 v246, v244
    v_mfma_f32_16x16x32_bf16 v[140:143], a[220:223], a[24:27], v[140:143]
    s_barrier
    v_mfma_f32_16x16x32_bf16 v[196:199], a[220:223], a[28:31], v[196:199]
    buffer_load_dwordx4 a[76:79], v7, s[32:35], s78 offen offset:1024 sc1
    v_mfma_f32_16x16x32_bf16 v[144:147], a[224:227], a[24:27], v[144:147]
    ds_read_b128 a[240:243], v3 offset:32768
    v_mov_b32 v247, v245
    v_mfma_f32_16x16x32_bf16 v[200:203], a[224:227], a[28:31], v[200:203]
    s_add_u32 m0, s65, 8192
    ds_read_b128 a[244:247], v3 offset:33792
    v_mov_b32 v250, v248
    v_mfma_f32_16x16x32_bf16 v[148:151], a[228:231], a[24:27], v[148:151]
    s_add_u32 s47, s70, 81920
    ds_read_b128 a[248:251], v3 offset:34816
    v_mov_b32 v251, v249
    v_mfma_f32_16x16x32_bf16 v[204:207], a[228:231], a[28:31], v[204:207]
    s_waitcnt lgkmcnt(3)
    buffer_load_dwordx4 v2, s[32:35], s47 offen sc1 lds
    v_mfma_f32_16x16x32_bf16 v[152:155], a[232:235], a[24:27], v[152:155]
    ds_read_b128 a[252:255], v3 offset:35840
    v_permlane16_swap_b32 v244, v246
    v_mfma_f32_16x16x32_bf16 v[208:211], a[232:235], a[28:31], v[208:211]
    ds_read_b128 a[208:211], v3 offset:36864
    v_permlane16_swap_b32 v245, v247
    v_mfma_f32_16x16x32_bf16 v[156:159], a[236:239], a[24:27], v[156:159]
    v_permlane16_swap_b32 v248, v250
    v_permlane16_swap_b32 v249, v251
    v_mfma_f32_16x16x32_bf16 v[212:215], a[236:239], a[28:31], v[212:215]
    s_waitcnt lgkmcnt(2)
    ds_read_b128 a[212:215], v3 offset:37888
    v_add_f32 v244, v244, v246
    v_mfma_f32_16x16x32_bf16 v[128:131], a[240:243], a[32:35], v[128:131]
    buffer_load_dwordx4 v2, s[32:35], s47 offen offset:1024 sc1 lds
    v_add_f32 v245, v245, v247
    v_mfma_f32_16x16x32_bf16 v[184:187], a[240:243], a[36:39], v[184:187]
    ds_read_b128 a[216:219], v3 offset:38912
    v_add_f32 v248, v248, v250
    v_mfma_f32_16x16x32_bf16 v[132:135], a[244:247], a[32:35], v[132:135]
    s_add_u32 m0, s65, 16384
    s_add_u32 s47, s70, 90112
    v_add_f32 v249, v249, v251
    v_mfma_f32_16x16x32_bf16 v[188:191], a[244:247], a[36:39], v[188:191]
    ds_read_b128 a[220:223], v3 offset:39936
    v_mov_b32 v246, v244
    v_mfma_f32_16x16x32_bf16 v[136:139], a[248:251], a[32:35], v[136:139]
    buffer_load_dwordx4 v2, s[32:35], s47 offen sc1 lds
    v_mov_b32 v247, v245
    v_mfma_f32_16x16x32_bf16 v[192:195], a[248:251], a[36:39], v[192:195]
    s_waitcnt lgkmcnt(2)
    ds_read_b128 a[224:227], v3 offset:40960
    v_mov_b32 v250, v248
    v_mfma_f32_16x16x32_bf16 v[140:143], a[252:255], a[32:35], v[140:143]
    v_mov_b32 v251, v249
    v_permlane32_swap_b32 v244, v246
    v_mfma_f32_16x16x32_bf16 v[196:199], a[252:255], a[36:39], v[196:199]
    ds_read_b128 a[228:231], v3 offset:41984
    v_permlane32_swap_b32 v245, v247
    v_mfma_f32_16x16x32_bf16 v[144:147], a[208:211], a[32:35], v[144:147]
    buffer_load_dwordx4 v2, s[32:35], s47 offen offset:1024 sc1 lds
    v_permlane32_swap_b32 v248, v250
    v_mfma_f32_16x16x32_bf16 v[200:203], a[208:211], a[36:39], v[200:203]
    ds_read_b128 a[232:235], v3 offset:43008
    v_permlane32_swap_b32 v249, v251
    v_mfma_f32_16x16x32_bf16 v[148:151], a[212:215], a[32:35], v[148:151]
    v_add_f32 v244, v244, v246
    v_add_f32 v245, v245, v247
    v_mfma_f32_16x16x32_bf16 v[204:207], a[212:215], a[36:39], v[204:207]
    s_waitcnt lgkmcnt(2)
    ds_read_b128 a[236:239], v3 offset:44032
    v_add_f32 v248, v248, v250
    v_mfma_f32_16x16x32_bf16 v[152:155], a[216:219], a[32:35], v[152:155]
    buffer_load_dwordx4 a[80:83], v2, s[32:35], s78 offen offset:2048 sc1
    v_mfma_f32_16x16x32_bf16 v[208:211], a[216:219], a[36:39], v[208:211]
    ds_read_b128 a[240:243], v3 offset:45056
    v_add_f32 v249, v249, v251
    v_mfma_f32_16x16x32_bf16 v[156:159], a[220:223], a[32:35], v[156:159]
    v_mul_f32 v244, 0xbacccccd, v244
    v_mul_f32 v248, 0xbacccccd, v248
    v_mfma_f32_16x16x32_bf16 v[212:215], a[220:223], a[36:39], v[212:215]
    s_waitcnt vmcnt(13) lgkmcnt(2)
    ds_read_b128 a[244:247], v3 offset:46080
    v_mul_f32 v245, 0x3acccccd, v245
    v_mfma_f32_16x16x32_bf16 v[128:131], a[224:227], a[40:43], v[128:131]
    v_mul_f32 v249, 0x3acccccd, v249
    v_fma_f32 v245, -v244, v244, v245
    v_mfma_f32_16x16x32_bf16 v[184:187], a[224:227], a[44:47], v[184:187]
    buffer_load_dwordx4 a[84:87], v7, s[32:35], s78 offen offset:2048 sc1
    v_mfma_f32_16x16x32_bf16 v[132:135], a[228:231], a[40:43], v[132:135]
    ds_read_b128 a[248:251], v3 offset:47104
    v_fma_f32 v249, -v248, v248, v249
    v_mfma_f32_16x16x32_bf16 v[188:191], a[228:231], a[44:47], v[188:191]
    ds_read_b128 a[252:255], v3 offset:48128
    v_max_f32 v245, 0, v245
    v_mfma_f32_16x16x32_bf16 v[136:139], a[232:235], a[40:43], v[136:139]
    v_max_f32 v249, 0, v249
    v_add_f32 v245, 0x3727c5ac, v245
    v_mfma_f32_16x16x32_bf16 v[192:195], a[232:235], a[44:47], v[192:195]
    s_waitcnt lgkmcnt(2)
    buffer_load_dwordx4 a[88:91], v2, s[32:35], s78 offen offset:3072 sc1
    v_mfma_f32_16x16x32_bf16 v[140:143], a[236:239], a[40:43], v[140:143]
    s_barrier
    v_mfma_f32_16x16x32_bf16 v[196:199], a[236:239], a[44:47], v[196:199]
    ds_read_b128 a[208:211], v3 offset:49152
    v_add_f32 v249, 0x3727c5ac, v249
    v_mfma_f32_16x16x32_bf16 v[144:147], a[240:243], a[40:43], v[144:147]
    ds_read_b128 a[212:215], v3 offset:50176
    v_rcp_f32 v246, v245
    v_mfma_f32_16x16x32_bf16 v[200:203], a[240:243], a[44:47], v[200:203]
    buffer_load_dwordx4 a[92:95], v7, s[32:35], s78 offen offset:3072 sc1
    v_mfma_f32_16x16x32_bf16 v[148:151], a[244:247], a[40:43], v[148:151]
    ds_read_b128 a[216:219], v3 offset:51200
    v_rcp_f32 v250, v249
    v_mfma_f32_16x16x32_bf16 v[204:207], a[244:247], a[44:47], v[204:207]
    s_waitcnt lgkmcnt(3)
    ds_read_b128 a[220:223], v3 offset:52224
    v_sqrt_f32 v245, v245
    v_mfma_f32_16x16x32_bf16 v[152:155], a[248:251], a[40:43], v[152:155]
    s_add_u32 m0, s65, 24576
    s_add_u32 s47, s70, 98304
    v_sqrt_f32 v249, v249
    v_mfma_f32_16x16x32_bf16 v[208:211], a[248:251], a[44:47], v[208:211]
    buffer_load_dwordx4 v2, s[32:35], s47 offen sc1 lds
    v_mfma_f32_16x16x32_bf16 v[156:159], a[252:255], a[40:43], v[156:159]
    ds_read_b128 a[224:227], v3 offset:53248
    ds_write_b32 v37, v246 offset:0
    v_mfma_f32_16x16x32_bf16 v[212:215], a[252:255], a[44:47], v[212:215]
    s_waitcnt vmcnt(15) lgkmcnt(3)
    ds_read_b128 a[228:231], v3 offset:54272
    ds_write_b32 v37, v250 offset:64
    v_mfma_f32_16x16x32_bf16 v[128:131], a[208:211], a[48:51], v[128:131]
    ds_read_b128 v[64:67], v36 offset:0
    ds_read_b128 v[68:71], v36 offset:896
    v_mfma_f32_16x16x32_bf16 v[184:187], a[208:211], a[52:55], v[184:187]
    ds_read_b128 a[232:235], v3 offset:55296
    ds_read_b128 v[72:75], v36 offset:64
    v_mfma_f32_16x16x32_bf16 v[132:135], a[212:215], a[48:51], v[132:135]
    buffer_load_dwordx4 v2, s[32:35], s47 offen offset:1024 sc1 lds
    v_mfma_f32_16x16x32_bf16 v[188:191], a[212:215], a[52:55], v[188:191]
    ds_read_b128 a[236:239], v3 offset:56320
    ds_read_b128 v[76:79], v36 offset:960
    v_mfma_f32_16x16x32_bf16 v[136:139], a[216:219], a[48:51], v[136:139]
    s_add_u32 m0, s65, 32768
    s_add_u32 s47, s70, 106496
    ds_read_b128 v[80:83], v36 offset:128
    v_mfma_f32_16x16x32_bf16 v[192:195], a[216:219], a[52:55], v[192:195]
    s_waitcnt lgkmcnt(8)
    ds_read_b128 a[240:243], v3 offset:57344
    ds_read_b128 v[84:87], v36 offset:1024
    v_mfma_f32_16x16x32_bf16 v[140:143], a[220:223], a[48:51], v[140:143]
    buffer_load_dwordx4 v2, s[32:35], s47 offen sc1 lds
    v_mfma_f32_16x16x32_bf16 v[196:199], a[220:223], a[52:55], v[196:199]
    ds_read_b128 a[244:247], v3 offset:58368
    ds_read_b128 v[88:91], v36 offset:192
    v_mfma_f32_16x16x32_bf16 v[144:147], a[224:227], a[48:51], v[144:147]
    ds_read_b128 v[92:95], v36 offset:1088
    ds_read_b128 v[96:99], v36 offset:256
    v_mfma_f32_16x16x32_bf16 v[200:203], a[224:227], a[52:55], v[200:203]
    s_waitcnt lgkmcnt(8)
    ds_read_b128 a[248:251], v3 offset:59392
    ds_read_b128 v[100:103], v36 offset:1152
    v_mfma_f32_16x16x32_bf16 v[148:151], a[228:231], a[48:51], v[148:151]
    buffer_load_dwordx4 v2, s[32:35], s47 offen offset:1024 sc1 lds
    v_mfma_f32_16x16x32_bf16 v[204:207], a[228:231], a[52:55], v[204:207]
    ds_read_b128 a[252:255], v3 offset:60416
    ds_read_b128 v[104:107], v36 offset:320
    v_mfma_f32_16x16x32_bf16 v[152:155], a[232:235], a[48:51], v[152:155]
    s_add_u32 s78, s48, 806912
    ds_read_b128 v[108:111], v36 offset:1216
    ds_read_b128 v[112:115], v36 offset:384
    v_mfma_f32_16x16x32_bf16 v[208:211], a[232:235], a[52:55], v[208:211]
    s_waitcnt lgkmcnt(9)
    ds_read_b128 a[208:211], v3 offset:61440
    ds_read_b128 v[116:119], v36 offset:1280
    v_mfma_f32_16x16x32_bf16 v[156:159], a[236:239], a[48:51], v[156:159]
    buffer_load_dwordx4 a[96:99], v2, s[32:35], s78 offen offset:0 sc1
    v_mfma_f32_16x16x32_bf16 v[212:215], a[236:239], a[52:55], v[212:215]
    s_waitcnt vmcnt(17) lgkmcnt(7)
    ds_read_b128 a[212:215], v3 offset:62464
    ds_read_b128 v[120:123], v36 offset:448
    v_mfma_f32_16x16x32_bf16 v[128:131], a[240:243], a[56:59], v[128:131]
    ds_read_b128 v[124:127], v36 offset:1344
    v_mfma_f32_16x16x32_bf16 v[184:187], a[240:243], a[60:63], v[184:187]
    ds_read_b128 a[216:219], v3 offset:63488
    v_mfma_f32_16x16x32_bf16 v[132:135], a[244:247], a[56:59], v[132:135]
    v_mfma_f32_16x16x32_bf16 v[188:191], a[244:247], a[60:63], v[188:191]
    buffer_load_dwordx4 a[100:103], v7, s[32:35], s78 offen offset:0 sc1
    v_mfma_f32_16x16x32_bf16 v[136:139], a[248:251], a[56:59], v[136:139]
    ds_read_b128 a[220:223], v3 offset:64512
    v_mfma_f32_16x16x32_bf16 v[192:195], a[248:251], a[60:63], v[192:195]
    s_waitcnt lgkmcnt(4)
    s_waitcnt lgkmcnt(2)
    v_fmac_f32 v128, v64, v244
    v_mfma_f32_16x16x32_bf16 v[140:143], a[252:255], a[56:59], v[140:143]
    s_barrier
    v_mfma_f32_16x16x32_bf16 v[196:199], a[252:255], a[60:63], v[196:199]
    buffer_load_dwordx4 a[104:107], v2, s[32:35], s78 offen offset:1024 sc1
    v_mfma_f32_16x16x32_bf16 v[144:147], a[208:211], a[56:59], v[144:147]
    ds_read_b128 a[224:227], v4 offset:0
    v_fmac_f32 v184, v64, v248
    v_mfma_f32_16x16x32_bf16 v[200:203], a[208:211], a[60:63], v[200:203]
    ds_read_b128 a[228:231], v4 offset:1024
    v_fmac_f32 v132, v72, v244
    v_mfma_f32_16x16x32_bf16 v[148:151], a[212:215], a[56:59], v[148:151]
    ds_read_b128 a[232:235], v4 offset:2048
    v_fmac_f32 v188, v72, v248
    v_mfma_f32_16x16x32_bf16 v[204:207], a[212:215], a[60:63], v[204:207]
    s_waitcnt lgkmcnt(3)
    buffer_load_dwordx4 a[108:111], v7, s[32:35], s78 offen offset:1024 sc1
    v_mfma_f32_16x16x32_bf16 v[152:155], a[216:219], a[56:59], v[152:155]
    ds_read_b128 a[236:239], v4 offset:3072
    v_fmac_f32 v136, v80, v244
    v_mfma_f32_16x16x32_bf16 v[208:211], a[216:219], a[60:63], v[208:211]
    s_add_u32 m0, s65, 40960
    ds_read_b128 a[240:243], v4 offset:4096
    v_fmac_f32 v192, v80, v248
    v_mfma_f32_16x16x32_bf16 v[156:159], a[220:223], a[56:59], v[156:159]
    s_add_u32 s47, s70, 114688
    v_fmac_f32 v140, v88, v244
    v_fmac_f32 v196, v88, v248
    v_mfma_f32_16x16x32_bf16 v[212:215], a[220:223], a[60:63], v[212:215]
    s_waitcnt vmcnt(18) lgkmcnt(2)
    buffer_load_dwordx4 v2, s[32:35], s47 offen sc1 lds
    v_mfma_f32_16x16x32_bf16 v[128:131], a[224:227], a[64:67], v[128:131]
    ds_read_b128 a[244:247], v4 offset:5120
    v_fmac_f32 v144, v96, v244
    v_mfma_f32_16x16x32_bf16 v[184:187], a[224:227], a[68:71], v[184:187]
    ds_read_b128 a[248:251], v4 offset:6144
    v_fmac_f32 v200, v96, v248
    v_mfma_f32_16x16x32_bf16 v[132:135], a[228:231], a[64:67], v[132:135]
    v_fmac_f32 v148, v104, v244
    v_fmac_f32 v204, v104, v248
    v_mfma_f32_16x16x32_bf16 v[188:191], a[228:231], a[68:71], v[188:191]
    ds_read_b128 a[252:255], v4 offset:7168
    v_fmac_f32 v152, v112, v244
    v_mfma_f32_16x16x32_bf16 v[136:139], a[232:235], a[64:67], v[136:139]
    buffer_load_dwordx4 v2, s[32:35], s47 offen offset:1024 sc1 lds
    v_fmac_f32 v208, v112, v248
    v_mfma_f32_16x16x32_bf16 v[192:195], a[232:235], a[68:71], v[192:195]
    s_waitcnt lgkmcnt(2)
    ds_read_b128 a[208:211], v2 offset:0
    v_fmac_f32 v156, v120, v244
    v_mfma_f32_16x16x32_bf16 v[140:143], a[236:239], a[64:67], v[140:143]
    s_add_u32 m0, s65, 49152
    s_add_u32 s47, s70, 122880
    v_fmac_f32 v212, v120, v248
    v_mfma_f32_16x16x32_bf16 v[196:199], a[236:239], a[68:71], v[196:199]
    ds_read_b128 a[212:215], v2 offset:1024
    v_fmac_f32 v129, v65, v244
    v_mfma_f32_16x16x32_bf16 v[144:147], a[240:243], a[64:67], v[144:147]
    buffer_load_dwordx4 v2, s[32:35], s47 offen sc1 lds
    v_fmac_f32 v185, v65, v248
    v_mfma_f32_16x16x32_bf16 v[200:203], a[240:243], a[68:71], v[200:203]
    ds_read_b128 a[216:219], v2 offset:2048
    v_fmac_f32 v133, v73, v244
    v_mfma_f32_16x16x32_bf16 v[148:151], a[244:247], a[64:67], v[148:151]
    v_fmac_f32 v189, v73, v248
    v_fmac_f32 v137, v81, v244
    v_mfma_f32_16x16x32_bf16 v[204:207], a[244:247], a[68:71], v[204:207]
    s_waitcnt lgkmcnt(2)
    ds_read_b128 a[220:223], v2 offset:3072
    v_fmac_f32 v193, v81, v248
    v_mfma_f32_16x16x32_bf16 v[152:155], a[248:251], a[64:67], v[152:155]
    buffer_load_dwordx4 v2, s[32:35], s47 offen offset:1024 sc1 lds
    v_fmac_f32 v141, v89, v244
    v_mfma_f32_16x16x32_bf16 v[208:211], a[248:251], a[68:71], v[208:211]
    ds_read_b128 a[224:227], v2 offset:4096
    v_fmac_f32 v197, v89, v248
    v_mfma_f32_16x16x32_bf16 v[156:159], a[252:255], a[64:67], v[156:159]
    v_fmac_f32 v145, v97, v244
    v_fmac_f32 v201, v97, v248
    v_mfma_f32_16x16x32_bf16 v[212:215], a[252:255], a[68:71], v[212:215]
    s_waitcnt vmcnt(20) lgkmcnt(2)
    ds_read_b128 a[228:231], v2 offset:5120
    v_fmac_f32 v149, v105, v244
    v_mfma_f32_16x16x32_bf16 v[128:131], a[208:211], a[72:75], v[128:131]
    buffer_load_dwordx4 a[112:115], v2, s[32:35], s78 offen offset:2048 sc1
    v_mfma_f32_16x16x32_bf16 v[184:187], a[208:211], a[76:79], v[184:187]
    ds_read_b128 a[232:235], v2 offset:6144
    v_fmac_f32 v205, v105, v248
    v_mfma_f32_16x16x32_bf16 v[132:135], a[212:215], a[72:75], v[132:135]
    v_fmac_f32 v153, v113, v244
    v_fmac_f32 v209, v113, v248
    v_mfma_f32_16x16x32_bf16 v[188:191], a[212:215], a[76:79], v[188:191]
    ds_read_b128 a[236:239], v2 offset:7168
    v_fmac_f32 v157, v121, v244
    v_mfma_f32_16x16x32_bf16 v[136:139], a[216:219], a[72:75], v[136:139]
    v_fmac_f32 v213, v121, v248
    v_fmac_f32 v130, v66, v244
    v_mfma_f32_16x16x32_bf16 v[192:195], a[216:219], a[76:79], v[192:195]
    s_waitcnt lgkmcnt(2)
    buffer_load_dwordx4 a[116:119], v7, s[32:35], s78 offen offset:2048 sc1
    v_mfma_f32_16x16x32_bf16 v[140:143], a[220:223], a[72:75], v[140:143]
    s_waitcnt vmcnt(18)
    s_barrier
    v_mfma_f32_16x16x32_bf16 v[196:199], a[220:223], a[76:79], v[196:199]
    ds_read_b128 a[240:243], v2 offset:8192
    v_fmac_f32 v186, v66, v248
    v_mfma_f32_16x16x32_bf16 v[144:147], a[224:227], a[72:75], v[144:147]
    ds_read_b128 a[244:247], v2 offset:9216
    v_fmac_f32 v134, v74, v244
    v_mfma_f32_16x16x32_bf16 v[200:203], a[224:227], a[76:79], v[200:203]
    buffer_load_dwordx4 a[120:123], v2, s[32:35], s78 offen offset:3072 sc1
    v_mfma_f32_16x16x32_bf16 v[148:151], a[228:231], a[72:75], v[148:151]
    ds_read_b128 a[248:251], v2 offset:10240
    v_fmac_f32 v190, v74, v248
    v_mfma_f32_16x16x32_bf16 v[204:207], a[228:231], a[76:79], v[204:207]
    s_waitcnt lgkmcnt(3)
    ds_read_b128 a[252:255], v2 offset:11264
    v_fmac_f32 v138, v82, v244
    v_mfma_f32_16x16x32_bf16 v[152:155], a[232:235], a[72:75], v[152:155]
    v_fmac_f32 v194, v82, v248
    v_fmac_f32 v142, v90, v244
    v_mfma_f32_16x16x32_bf16 v[208:211], a[232:235], a[76:79], v[208:211]
    buffer_load_dwordx4 a[124:127], v7, s[32:35], s78 offen offset:3072 sc1
    v_mfma_f32_16x16x32_bf16 v[156:159], a[236:239], a[72:75], v[156:159]
    ds_read_b128 a[208:211], v2 offset:12288
    v_fmac_f32 v198, v90, v248
    v_mfma_f32_16x16x32_bf16 v[212:215], a[236:239], a[76:79], v[212:215]
    s_waitcnt vmcnt(18) lgkmcnt(2)
    ds_read_b128 a[212:215], v2 offset:13312
    v_fmac_f32 v146, v98, v244
    v_mfma_f32_16x16x32_bf16 v[128:131], a[240:243], a[80:83], v[128:131]
    s_add_u32 m0, s65, 57344
    s_add_u32 s47, s70, 131072
    v_fmac_f32 v202, v98, v248
    v_mfma_f32_16x16x32_bf16 v[184:187], a[240:243], a[84:87], v[184:187]
    buffer_load_dwordx4 v2, s[32:35], s47 offen sc1 lds
    v_fmac_f32 v150, v106, v244
    v_mfma_f32_16x16x32_bf16 v[132:135], a[244:247], a[80:83], v[132:135]
    ds_read_b128 a[216:219], v2 offset:14336
    v_fmac_f32 v206, v106, v248
    v_mfma_f32_16x16x32_bf16 v[188:191], a[244:247], a[84:87], v[188:191]
    ds_read_b128 a[220:223], v2 offset:15360
    v_fmac_f32 v154, v114, v244
    v_mfma_f32_16x16x32_bf16 v[136:139], a[248:251], a[80:83], v[136:139]
    v_fmac_f32 v210, v114, v248
    v_fmac_f32 v158, v122, v244
    v_mfma_f32_16x16x32_bf16 v[192:195], a[248:251], a[84:87], v[192:195]
    s_waitcnt lgkmcnt(2)
    ds_read_b128 a[224:227], v2 offset:16384
    v_fmac_f32 v214, v122, v248
    v_mfma_f32_16x16x32_bf16 v[140:143], a[252:255], a[80:83], v[140:143]
    buffer_load_dwordx4 v2, s[32:35], s47 offen offset:1024 sc1 lds
    v_fmac_f32 v131, v67, v244
    v_mfma_f32_16x16x32_bf16 v[196:199], a[252:255], a[84:87], v[196:199]
    ds_read_b128 a[228:231], v2 offset:17408
    v_fmac_f32 v187, v67, v248
    v_mfma_f32_16x16x32_bf16 v[144:147], a[208:211], a[80:83], v[144:147]
    s_add_u32 m0, s65, 65536
    s_add_u32 s47, s70, 139264
    v_fmac_f32 v135, v75, v244
    v_mfma_f32_16x16x32_bf16 v[200:203], a[208:211], a[84:87], v[200:203]
    ds_read_b128 a[232:235], v2 offset:18432
    v_fmac_f32 v191, v75, v248
    v_mfma_f32_16x16x32_bf16 v[148:151], a[212:215], a[80:83], v[148:151]
    buffer_load_dwordx4 v2, s[32:35], s47 offen sc1 lds
    v_fmac_f32 v139, v83, v244
    v_mfma_f32_16x16x32_bf16 v[204:207], a[212:215], a[84:87], v[204:207]
    s_waitcnt lgkmcnt(2)
    ds_read_b128 a[236:239], v2 offset:19456
    v_fmac_f32 v195, v83, v248
    v_mfma_f32_16x16x32_bf16 v[152:155], a[216:219], a[80:83], v[152:155]
    v_fmac_f32 v143, v91, v244
    v_fmac_f32 v199, v91, v248
    v_mfma_f32_16x16x32_bf16 v[208:211], a[216:219], a[84:87], v[208:211]
    ds_read_b128 a[240:243], v2 offset:20480
    v_fmac_f32 v147, v99, v244
    v_mfma_f32_16x16x32_bf16 v[156:159], a[220:223], a[80:83], v[156:159]
    buffer_load_dwordx4 v2, s[32:35], s47 offen offset:1024 sc1 lds
    v_fmac_f32 v203, v99, v248
    v_mfma_f32_16x16x32_bf16 v[212:215], a[220:223], a[84:87], v[212:215]
    s_waitcnt vmcnt(20) lgkmcnt(2)
    ds_read_b128 a[244:247], v2 offset:21504
    v_fmac_f32 v151, v107, v244
    v_mfma_f32_16x16x32_bf16 v[128:131], a[224:227], a[88:91], v[128:131]
    s_add_u32 s78, s48, 819200
    v_fmac_f32 v207, v107, v248
    v_fmac_f32 v155, v115, v244
    v_mfma_f32_16x16x32_bf16 v[184:187], a[224:227], a[92:95], v[184:187]
    ds_read_b128 a[248:251], v2 offset:22528
    v_fmac_f32 v211, v115, v248
    v_mfma_f32_16x16x32_bf16 v[132:135], a[228:231], a[88:91], v[132:135]
    buffer_load_dwordx4 a[128:131], v2, s[32:35], s78 offen offset:0 sc1
    v_mfma_f32_16x16x32_bf16 v[188:191], a[228:231], a[92:95], v[188:191]
    ds_read_b128 a[252:255], v2 offset:23552
    v_fmac_f32 v159, v123, v244
    v_mfma_f32_16x16x32_bf16 v[136:139], a[232:235], a[88:91], v[136:139]
    v_fmac_f32 v215, v123, v248
    v_fmac_f32 v128, v68, v245
    v_mfma_f32_16x16x32_bf16 v[192:195], a[232:235], a[92:95], v[192:195]
    s_waitcnt lgkmcnt(2)
    v_fmac_f32 v184, v68, v249
    v_fmac_f32 v132, v76, v245
    v_mfma_f32_16x16x32_bf16 v[140:143], a[236:239], a[88:91], v[140:143]
    s_waitcnt vmcnt(17)
    s_barrier
    v_mfma_f32_16x16x32_bf16 v[196:199], a[236:239], a[92:95], v[196:199]
    buffer_load_dwordx4 a[132:135], v7, s[32:35], s78 offen offset:0 sc1
    v_mfma_f32_16x16x32_bf16 v[144:147], a[240:243], a[88:91], v[144:147]
    ds_read_b128 a[208:211], v2 offset:24576
    v_fmac_f32 v188, v76, v249
    v_mfma_f32_16x16x32_bf16 v[200:203], a[240:243], a[92:95], v[200:203]
    ds_read_b128 a[212:215], v2 offset:25600
    v_fmac_f32 v136, v84, v245
    v_mfma_f32_16x16x32_bf16 v[148:151], a[244:247], a[88:91], v[148:151]
    ds_read_b128 a[216:219], v2 offset:26624
    v_fmac_f32 v192, v84, v249
    v_mfma_f32_16x16x32_bf16 v[204:207], a[244:247], a[92:95], v[204:207]
    s_waitcnt lgkmcnt(3)
    buffer_load_dwordx4 a[136:139], v2, s[32:35], s78 offen offset:1024 sc1
    v_mfma_f32_16x16x32_bf16 v[152:155], a[248:251], a[88:91], v[152:155]
    ds_read_b128 a[220:223], v2 offset:27648
    v_fmac_f32 v140, v92, v245
    v_mfma_f32_16x16x32_bf16 v[208:211], a[248:251], a[92:95], v[208:211]
    ds_read_b128 a[224:227], v2 offset:28672
    v_fmac_f32 v196, v92, v249
    v_mfma_f32_16x16x32_bf16 v[156:159], a[252:255], a[88:91], v[156:159]
    v_fmac_f32 v144, v100, v245
    v_fmac_f32 v200, v100, v249
    v_mfma_f32_16x16x32_bf16 v[212:215], a[252:255], a[92:95], v[212:215]
    s_waitcnt vmcnt(17) lgkmcnt(2)
    buffer_load_dwordx4 a[140:143], v7, s[32:35], s78 offen offset:1024 sc1
    v_mfma_f32_16x16x32_bf16 v[128:131], a[208:211], a[96:99], v[128:131]
    ds_read_b128 a[228:231], v2 offset:29696
    v_fmac_f32 v148, v108, v245
    v_mfma_f32_16x16x32_bf16 v[184:187], a[208:211], a[100:103], v[184:187]
    s_add_u32 m0, s65, 73728
    ds_read_b128 a[232:235], v2 offset:30720
    v_fmac_f32 v204, v108, v249
    v_mfma_f32_16x16x32_bf16 v[132:135], a[212:215], a[96:99], v[132:135]
    s_add_u32 s47, s70, 147456
    v_fmac_f32 v152, v116, v245
    v_fmac_f32 v208, v116, v249
    v_mfma_f32_16x16x32_bf16 v[188:191], a[212:215], a[100:103], v[188:191]
    buffer_load_dwordx4 v2, s[32:35], s47 offen sc1 lds
    v_fmac_f32 v156, v124, v245
    v_mfma_f32_16x16x32_bf16 v[136:139], a[216:219], a[96:99], v[136:139]
    ds_read_b128 a[236:239], v2 offset:31744
    v_fmac_f32 v212, v124, v249
    v_mfma_f32_16x16x32_bf16 v[192:195], a[216:219], a[100:103], v[192:195]
    s_waitcnt lgkmcnt(2)
    ds_read_b128 a[240:243], v2 offset:32768
    v_fmac_f32 v129, v69, v245
    v_mfma_f32_16x16x32_bf16 v[140:143], a[220:223], a[96:99], v[140:143]
    v_fmac_f32 v185, v69, v249
    v_fmac_f32 v133, v77, v245
    v_mfma_f32_16x16x32_bf16 v[196:199], a[220:223], a[100:103], v[196:199]
    ds_read_b128 a[244:247], v2 offset:33792
    v_fmac_f32 v189, v77, v249
    v_mfma_f32_16x16x32_bf16 v[144:147], a[224:227], a[96:99], v[144:147]
    buffer_load_dwordx4 v2, s[32:35], s47 offen offset:1024 sc1 lds
    v_fmac_f32 v137, v85, v245
    v_mfma_f32_16x16x32_bf16 v[200:203], a[224:227], a[100:103], v[200:203]
    ds_read_b128 a[248:251], v2 offset:34816
    v_fmac_f32 v193, v85, v249
    v_mfma_f32_16x16x32_bf16 v[148:151], a[228:231], a[96:99], v[148:151]
    s_add_u32 m0, s65, 139264
    s_add_u32 s47, s70, 155648
    v_fmac_f32 v141, v93, v245
    v_mfma_f32_16x16x32_bf16 v[204:207], a[228:231], a[100:103], v[204:207]
    s_waitcnt lgkmcnt(2)
    ds_read_b128 a[252:255], v2 offset:35840
    v_fmac_f32 v197, v93, v249
    v_mfma_f32_16x16x32_bf16 v[152:155], a[232:235], a[96:99], v[152:155]
    buffer_load_dwordx4 v2, s[32:35], s47 offen sc1 lds
    v_fmac_f32 v145, v101, v245
    v_mfma_f32_16x16x32_bf16 v[208:211], a[232:235], a[100:103], v[208:211]
    ds_read_b128 a[208:211], v2 offset:36864
    v_fmac_f32 v201, v101, v249
    v_mfma_f32_16x16x32_bf16 v[156:159], a[236:239], a[96:99], v[156:159]
    v_fmac_f32 v149, v109, v245
    v_fmac_f32 v205, v109, v249
    v_mfma_f32_16x16x32_bf16 v[212:215], a[236:239], a[100:103], v[212:215]
    s_waitcnt vmcnt(19) lgkmcnt(2)
    ds_read_b128 a[212:215], v2 offset:37888
    v_fmac_f32 v153, v117, v245
    v_mfma_f32_16x16x32_bf16 v[128:131], a[240:243], a[104:107], v[128:131]
    buffer_load_dwordx4 v2, s[32:35], s47 offen offset:1024 sc1 lds
    v_fmac_f32 v209, v117, v249
    v_mfma_f32_16x16x32_bf16 v[184:187], a[240:243], a[108:111], v[184:187]
    ds_read_b128 a[216:219], v2 offset:38912
    v_fmac_f32 v157, v125, v245
    v_mfma_f32_16x16x32_bf16 v[132:135], a[244:247], a[104:107], v[132:135]
    v_fmac_f32 v213, v125, v249
    v_fmac_f32 v194, v86, v249
    v_mfma_f32_16x16x32_bf16 v[188:191], a[244:247], a[108:111], v[188:191]
    ds_read_b128 a[220:223], v2 offset:39936
    v_fmac_f32 v130, v70, v245
    v_mfma_f32_16x16x32_bf16 v[136:139], a[248:251], a[104:107], v[136:139]
    buffer_load_dwordx4 a[144:147], v2, s[32:35], s78 offen offset:2048 sc1
    v_mfma_f32_16x16x32_bf16 v[192:195], a[248:251], a[108:111], v[192:195]
    s_waitcnt lgkmcnt(2)
    v_fmac_f32 v186, v70, v249
    v_fmac_f32 v134, v78, v245
    v_mfma_f32_16x16x32_bf16 v[140:143], a[252:255], a[104:107], v[140:143]
    s_waitcnt vmcnt(17)
    s_barrier
    v_mfma_f32_16x16x32_bf16 v[196:199], a[252:255], a[108:111], v[196:199]
    ds_read_b128 a[224:227], v2 offset:40960
    v_fmac_f32 v190, v78, v249
    v_mfma_f32_16x16x32_bf16 v[144:147], a[208:211], a[104:107], v[144:147]
    ds_read_b128 a[228:231], v2 offset:41984
    v_fmac_f32 v138, v86, v245
    v_mfma_f32_16x16x32_bf16 v[200:203], a[208:211], a[108:111], v[200:203]
    buffer_load_dwordx4 a[148:151], v7, s[32:35], s78 offen offset:2048 sc1
    v_mfma_f32_16x16x32_bf16 v[148:151], a[212:215], a[104:107], v[148:151]
    ds_read_b128 a[232:235], v2 offset:43008
    v_fmac_f32 v142, v94, v245
    v_mfma_f32_16x16x32_bf16 v[204:207], a[212:215], a[108:111], v[204:207]
    s_waitcnt lgkmcnt(3)
    ds_read_b128 a[236:239], v2 offset:44032
    v_fmac_f32 v198, v94, v249
    v_mfma_f32_16x16x32_bf16 v[152:155], a[216:219], a[104:107], v[152:155]
    v_fmac_f32 v146, v102, v245
    v_fmac_f32 v202, v102, v249
    v_mfma_f32_16x16x32_bf16 v[208:211], a[216:219], a[108:111], v[208:211]
    buffer_load_dwordx4 a[152:155], v2, s[32:35], s78 offen offset:3072 sc1
    v_mfma_f32_16x16x32_bf16 v[156:159], a[220:223], a[104:107], v[156:159]
    ds_read_b128 a[240:243], v2 offset:45056
    v_fmac_f32 v150, v110, v245
    v_mfma_f32_16x16x32_bf16 v[212:215], a[220:223], a[108:111], v[212:215]
    s_waitcnt vmcnt(17) lgkmcnt(2)
    ds_read_b128 a[244:247], v2 offset:46080
    v_fmac_f32 v206, v110, v249
    v_mfma_f32_16x16x32_bf16 v[128:131], a[224:227], a[112:115], v[128:131]
    v_fmac_f32 v154, v118, v245
    v_fmac_f32 v210, v118, v249
    v_mfma_f32_16x16x32_bf16 v[184:187], a[224:227], a[116:119], v[184:187]
    buffer_load_dwordx4 a[156:159], v7, s[32:35], s78 offen offset:3072 sc1
    v_mfma_f32_16x16x32_bf16 v[132:135], a[228:231], a[112:115], v[132:135]
    ds_read_b128 a[248:251], v2 offset:47104
    v_fmac_f32 v158, v126, v245
    v_mfma_f32_16x16x32_bf16 v[188:191], a[228:231], a[116:119], v[188:191]
    s_add_u32 m0, s65, 147456
    ds_read_b128 a[252:255], v2 offset:48128
    v_fmac_f32 v214, v126, v249
    v_mfma_f32_16x16x32_bf16 v[136:139], a[232:235], a[112:115], v[136:139]
    s_add_u32 s47, s70, 163840
    v_fmac_f32 v131, v71, v245
    v_fmac_f32 v187, v71, v249
    v_mfma_f32_16x16x32_bf16 v[192:195], a[232:235], a[116:119], v[192:195]
    s_waitcnt lgkmcnt(2)
    buffer_load_dwordx4 v240, s[32:35], s47 offen sc1 lds
    v_mfma_f32_16x16x32_bf16 v[140:143], a[236:239], a[112:115], v[140:143]
    ds_read_b128 a[208:211], v2 offset:49152
    v_fmac_f32 v135, v79, v245
    v_mfma_f32_16x16x32_bf16 v[196:199], a[236:239], a[116:119], v[196:199]
    ds_read_b128 a[212:215], v2 offset:50176
    v_fmac_f32 v191, v79, v249
    v_mfma_f32_16x16x32_bf16 v[144:147], a[240:243], a[112:115], v[144:147]
    v_fmac_f32 v139, v87, v245
    v_fmac_f32 v195, v87, v249
    v_mfma_f32_16x16x32_bf16 v[200:203], a[240:243], a[116:119], v[200:203]
    ds_read_b128 a[216:219], v2 offset:51200
    v_fmac_f32 v143, v95, v245
    v_mfma_f32_16x16x32_bf16 v[148:151], a[244:247], a[112:115], v[148:151]
    buffer_load_dwordx4 v240, s[32:35], s47 offen offset:1024 sc1 lds
    v_fmac_f32 v199, v95, v249
    v_mfma_f32_16x16x32_bf16 v[204:207], a[244:247], a[116:119], v[204:207]
    s_waitcnt lgkmcnt(2)
    ds_read_b128 a[220:223], v2 offset:52224
    v_fmac_f32 v147, v103, v245
    v_mfma_f32_16x16x32_bf16 v[152:155], a[248:251], a[112:115], v[152:155]
    s_add_u32 m0, s65, 81920
    s_add_u32 s47, s70, 172032
    v_fmac_f32 v203, v103, v249
    v_mfma_f32_16x16x32_bf16 v[208:211], a[248:251], a[116:119], v[208:211]
    ds_read_b128 a[224:227], v2 offset:53248
    v_fmac_f32 v151, v111, v245
    v_mfma_f32_16x16x32_bf16 v[156:159], a[252:255], a[112:115], v[156:159]
    buffer_load_dwordx4 v241, s[32:35], s47 offen sc1 lds
    v_fmac_f32 v207, v111, v249
    v_mfma_f32_16x16x32_bf16 v[212:215], a[252:255], a[116:119], v[212:215]
    s_waitcnt vmcnt(19) lgkmcnt(2)
    ds_read_b128 a[228:231], v2 offset:54272
    v_fmac_f32 v155, v119, v245
    v_mfma_f32_16x16x32_bf16 v[128:131], a[208:211], a[120:123], v[128:131]
    v_fmac_f32 v211, v119, v249
    v_fmac_f32 v159, v127, v245
    v_mfma_f32_16x16x32_bf16 v[184:187], a[208:211], a[124:127], v[184:187]
    ds_read_b128 a[232:235], v2 offset:55296
    v_fmac_f32 v215, v127, v249
    v_mfma_f32_16x16x32_bf16 v[132:135], a[212:215], a[120:123], v[132:135]
    buffer_load_dwordx4 v241, s[32:35], s47 offen offset:1024 sc1 lds
    v_mfma_f32_16x16x32_bf16 v[188:191], a[212:215], a[124:127], v[188:191]
    ds_read_b128 a[236:239], v2 offset:56320
    ds_read_b128 v[64:67], v36 offset:512
    v_mfma_f32_16x16x32_bf16 v[136:139], a[216:219], a[120:123], v[136:139]
    s_add_u32 m0, s65, 90112
    s_add_u32 s47, s70, 180224
    ds_read_b128 v[68:71], v36 offset:1408
    v_mfma_f32_16x16x32_bf16 v[192:195], a[216:219], a[124:127], v[192:195]
    s_waitcnt lgkmcnt(4)
    ds_read_b128 v[72:75], v36 offset:576
    ds_read_b128 v[76:79], v36 offset:1472
    v_mfma_f32_16x16x32_bf16 v[140:143], a[220:223], a[120:123], v[140:143]
    s_waitcnt vmcnt(16)
    s_barrier
    v_mfma_f32_16x16x32_bf16 v[196:199], a[220:223], a[124:127], v[196:199]
    buffer_load_dwordx4 v242, s[32:35], s47 offen sc1 lds
    v_mfma_f32_16x16x32_bf16 v[144:147], a[224:227], a[120:123], v[144:147]
    ds_read_b128 a[240:243], v2 offset:57344
    ds_read_b128 v[80:83], v36 offset:640
    v_mfma_f32_16x16x32_bf16 v[200:203], a[224:227], a[124:127], v[200:203]
    ds_read_b128 a[244:247], v2 offset:58368
    ds_read_b128 v[84:87], v36 offset:1536
    v_mfma_f32_16x16x32_bf16 v[148:151], a[228:231], a[120:123], v[148:151]
    ds_read_b128 a[248:251], v2 offset:59392
L_pad5:
    s_cbranch_execz L_hopped
    ds_read_b128 v[88:91], v36 offset:704
    v_mfma_f32_16x16x32_bf16 v[204:207], a[228:231], a[124:127], v[204:207]
    s_waitcnt lgkmcnt(10)
    buffer_load_dwordx4 v242, s[32:35], s47 offen offset:1024 sc1 lds
    v_mfma_f32_16x16x32_bf16 v[152:155], a[232:235], a[120:123], v[152:155]
    ds_read_b128 a[252:255], v2 offset:60416
    ds_read_b128 v[92:95], v36 offset:1600
    v_mfma_f32_16x16x32_bf16 v[208:211], a[232:235], a[124:127], v[208:211]
    s_add_u32 m0, s65, 98304
    ds_read_b128 a[208:211], v2 offset:61440
    ds_read_b128 v[96:99], v36 offset:768
    v_mfma_f32_16x16x32_bf16 v[156:159], a[236:239], a[120:123], v[156:159]
    s_waitcnt lgkmcnt(7)
    s_add_u32 s47, s70, 188416
    ds_read_b128 v[100:103], v36 offset:1664
    v_mfma_f32_16x16x32_bf16 v[212:215], a[236:239], a[124:127], v[212:215]
    s_waitcnt vmcnt(16) lgkmcnt(6)
    buffer_load_dwordx4 v240, s[32:35], s47 offen sc1 lds
    v_mfma_f32_16x16x32_bf16 v[128:131], a[240:243], a[128:131], v[128:131]
    ds_read_b128 a[212:215], v2 offset:62464
    ds_read_b128 v[104:107], v36 offset:832
    v_mfma_f32_16x16x32_bf16 v[184:187], a[240:243], a[132:135], v[184:187]
    ds_read_b128 a[216:219], v2 offset:63488
    ds_read_b128 v[108:111], v36 offset:1728
    v_mfma_f32_16x16x32_bf16 v[132:135], a[244:247], a[128:131], v[132:135]
    s_and_b32 s83, s62, 12
    s_add_u32 s83, s83, s62
    v_mfma_f32_16x16x32_bf16 v[188:191], a[244:247], a[132:135], v[188:191]
    s_lshl_b32 s83, s83, 11
    buffer_load_dwordx4 v240, s[32:35], s47 offen offset:1024 sc1 lds
    v_mfma_f32_16x16x32_bf16 v[136:139], a[248:251], a[128:131], v[136:139]
    s_add_u32 s83, s83, s82
    ds_read_b128 a[220:223], v2 offset:64512
    v_mfma_f32_16x16x32_bf16 v[192:195], a[248:251], a[132:135], v[192:195]
    s_waitcnt lgkmcnt(4)
    ds_read_b128 a[224:227], v3 offset:0
    v_mfma_f32_16x16x32_bf16 v[140:143], a[252:255], a[128:131], v[140:143]
    s_add_u32 m0, s65, 106496
    s_add_u32 s47, s70, 196608
    v_mfma_f32_16x16x32_bf16 v[196:199], a[252:255], a[132:135], v[196:199]
    s_add_u32 s84, s83, 114688
    buffer_load_dwordx4 v241, s[32:35], s47 offen sc1 lds
    v_mfma_f32_16x16x32_bf16 v[144:147], a[208:211], a[128:131], v[144:147]
    s_and_b32 s85, s73, 7
    ds_read_b128 a[228:231], v3 offset:1024
    v_mfma_f32_16x16x32_bf16 v[200:203], a[208:211], a[132:135], v[200:203]
    s_mul_i32 s85, s85, 114688
    ds_read_b128 a[232:235], v3 offset:2048
    v_mfma_f32_16x16x32_bf16 v[148:151], a[212:215], a[128:131], v[148:151]
    s_add_u32 s85, s85, s45
    v_mfma_f32_16x16x32_bf16 v[204:207], a[212:215], a[132:135], v[204:207]
    s_waitcnt lgkmcnt(2)
    ds_read_b128 a[236:239], v3 offset:3072
    v_mfma_f32_16x16x32_bf16 v[152:155], a[216:219], a[128:131], v[152:155]
    buffer_load_dwordx4 v241, s[32:35], s47 offen offset:1024 sc1 lds
    v_mfma_f32_16x16x32_bf16 v[208:211], a[216:219], a[132:135], v[208:211]
    ds_read_b128 a[240:243], v3 offset:4096
    v_mfma_f32_16x16x32_bf16 v[156:159], a[220:223], a[128:131], v[156:159]
    s_add_u32 m0, s65, 114688
    s_add_u32 s47, s70, 204800
    v_mfma_f32_16x16x32_bf16 v[212:215], a[220:223], a[132:135], v[212:215]
    s_waitcnt vmcnt(18) lgkmcnt(2)
    ds_read_b128 a[244:247], v3 offset:5120
    v_mfma_f32_16x16x32_bf16 v[128:131], a[224:227], a[136:139], v[128:131]
    buffer_load_dwordx4 v242, s[32:35], s47 offen sc1 lds
    v_mfma_f32_16x16x32_bf16 v[184:187], a[224:227], a[140:143], v[184:187]
    ds_read_b128 a[248:251], v3 offset:6144
    v_mfma_f32_16x16x32_bf16 v[132:135], a[228:231], a[136:139], v[132:135]
    v_mfma_f32_16x16x32_bf16 v[188:191], a[228:231], a[140:143], v[188:191]
    ds_read_b128 a[252:255], v3 offset:7168
    v_mfma_f32_16x16x32_bf16 v[136:139], a[232:235], a[136:139], v[136:139]
    buffer_load_dwordx4 v242, s[32:35], s47 offen offset:1024 sc1 lds
    v_mfma_f32_16x16x32_bf16 v[192:195], a[232:235], a[140:143], v[192:195]
    s_waitcnt lgkmcnt(2)
    v_mfma_f32_16x16x32_bf16 v[140:143], a[236:239], a[136:139], v[140:143]
    s_waitcnt vmcnt(16)
    s_barrier
    v_mfma_f32_16x16x32_bf16 v[196:199], a[236:239], a[140:143], v[196:199]
    s_add_u32 m0, s65, 122880
    ds_read_b128 a[208:211], v3 offset:8192
    v_mfma_f32_16x16x32_bf16 v[144:147], a[240:243], a[136:139], v[144:147]
    s_add_u32 s47, s70, 212992
    ds_read_b128 a[212:215], v3 offset:9216
    v_mfma_f32_16x16x32_bf16 v[200:203], a[240:243], a[140:143], v[200:203]
    buffer_load_dwordx4 v240, s[32:35], s47 offen sc1 lds
    v_mfma_f32_16x16x32_bf16 v[148:151], a[244:247], a[136:139], v[148:151]
    ds_read_b128 a[216:219], v3 offset:10240
    v_mfma_f32_16x16x32_bf16 v[204:207], a[244:247], a[140:143], v[204:207]
    s_waitcnt lgkmcnt(3)
    ds_read_b128 a[220:223], v3 offset:11264
    v_mfma_f32_16x16x32_bf16 v[152:155], a[248:251], a[136:139], v[152:155]
    v_mfma_f32_16x16x32_bf16 v[208:211], a[248:251], a[140:143], v[208:211]
    buffer_load_dwordx4 v240, s[32:35], s47 offen offset:1024 sc1 lds
    v_mfma_f32_16x16x32_bf16 v[156:159], a[252:255], a[136:139], v[156:159]
    ds_read_b128 a[224:227], v3 offset:12288
    v_mfma_f32_16x16x32_bf16 v[212:215], a[252:255], a[140:143], v[212:215]
    s_waitcnt vmcnt(16) lgkmcnt(2)
    ds_read_b128 a[228:231], v3 offset:13312
    v_mfma_f32_16x16x32_bf16 v[128:131], a[208:211], a[144:147], v[128:131]
    s_add_u32 m0, s65, 131072
    s_add_u32 s47, s70, 221184
    v_mfma_f32_16x16x32_bf16 v[184:187], a[208:211], a[148:151], v[184:187]
    buffer_load_dwordx4 v241, s[32:35], s47 offen sc1 lds
    v_mfma_f32_16x16x32_bf16 v[132:135], a[212:215], a[144:147], v[132:135]
    ds_read_b128 a[232:235], v3 offset:14336
    v_mfma_f32_16x16x32_bf16 v[188:191], a[212:215], a[148:151], v[188:191]
    ds_read_b128 a[236:239], v3 offset:15360
    v_mfma_f32_16x16x32_bf16 v[136:139], a[216:219], a[144:147], v[136:139]
    v_mfma_f32_16x16x32_bf16 v[192:195], a[216:219], a[148:151], v[192:195]
    s_waitcnt lgkmcnt(2)
    buffer_load_dwordx4 v241, s[32:35], s47 offen offset:1024 sc1 lds
    v_mfma_f32_16x16x32_bf16 v[140:143], a[220:223], a[144:147], v[140:143]
    ds_read_b128 a[240:243], v4 offset:8192
    v_mfma_f32_16x16x32_bf16 v[196:199], a[220:223], a[148:151], v[196:199]
    s_add_u32 m0, s65, 0
    ds_read_b128 a[244:247], v4 offset:9216
    v_mfma_f32_16x16x32_bf16 v[144:147], a[224:227], a[144:147], v[144:147]
    s_add_u32 s47, s70, 229376
    v_mfma_f32_16x16x32_bf16 v[200:203], a[224:227], a[148:151], v[200:203]
    buffer_load_dwordx4 v242, s[32:35], s47 offen sc1 lds
    v_mfma_f32_16x16x32_bf16 v[148:151], a[228:231], a[144:147], v[148:151]
    ds_read_b128 a[248:251], v4 offset:10240
    v_mfma_f32_16x16x32_bf16 v[204:207], a[228:231], a[148:151], v[204:207]
    s_waitcnt lgkmcnt(2)
    ds_read_b128 a[252:255], v4 offset:11264
    v_mfma_f32_16x16x32_bf16 v[152:155], a[232:235], a[144:147], v[152:155]
    s_add_u32 s76, s2, s60
    s_cmp_lg_u32 s76, 0
    s_cbranch_scc1 L_noepoch_32
    v_lshlrev_b32 v23, 7, v1
    s_mov_b32 s76, 360448
    buffer_load_dword v56, v23, s[32:35], s76 offen sc1
    s_mov_b32 s76, 368640
    buffer_load_dword v57, v23, s[32:35], s76 offen sc1
    s_mov_b32 s76, 376832
    buffer_load_dword v58, v23, s[32:35], s76 offen sc1
    s_mov_b32 s76, 385024
    buffer_load_dword v59, v23, s[32:35], s76 offen sc1
L_noepoch_32:
    v_mfma_f32_16x16x32_bf16 v[208:211], a[232:235], a[148:151], v[208:211]
    ds_read_b128 a[208:211], v4 offset:12288
    v_mfma_f32_16x16x32_bf16 v[156:159], a[236:239], a[144:147], v[156:159]
    buffer_load_dwordx4 v242, s[32:35], s47 offen offset:1024 sc1 lds
    v_mfma_f32_16x16x32_bf16 v[212:215], a[236:239], a[148:151], v[212:215]
    s_waitcnt vmcnt(18) lgkmcnt(2)
    ds_read_b128 a[212:215], v4 offset:13312
    v_mfma_f32_16x16x32_bf16 v[128:131], a[240:243], a[152:155], v[128:131]
    s_add_u32 m0, s65, 8192
    s_add_u32 s47, s70, 237568
    v_mfma_f32_16x16x32_bf16 v[184:187], a[240:243], a[156:159], v[184:187]
    ds_read_b128 a[216:219], v4 offset:14336
    v_mfma_f32_16x16x32_bf16 v[132:135], a[244:247], a[152:155], v[132:135]
    buffer_load_dwordx4 v240, s[32:35], s47 offen sc1 lds
    v_mfma_f32_16x16x32_bf16 v[188:191], a[244:247], a[156:159], v[188:191]
    ds_read_b128 a[220:223], v4 offset:15360
    v_mfma_f32_16x16x32_bf16 v[136:139], a[248:251], a[152:155], v[136:139]
    v_mfma_f32_16x16x32_bf16 v[192:195], a[248:251], a[156:159], v[192:195]
    s_waitcnt lgkmcnt(2)
    v_mfma_f32_16x16x32_bf16 v[140:143], a[252:255], a[152:155], v[140:143]
    s_waitcnt vmcnt(15)
    s_barrier
    v_mfma_f32_16x16x32_bf16 v[196:199], a[252:255], a[156:159], v[196:199]
    buffer_load_dwordx4 v240, s[32:35], s47 offen offset:1024 sc1 lds
    v_mfma_f32_16x16x32_bf16 v[144:147], a[208:211], a[152:155], v[144:147]
    ds_read_b128 a[224:227], v4 offset:16384
    v_mfma_f32_16x16x32_bf16 v[200:203], a[208:211], a[156:159], v[200:203]
    s_add_u32 m0, s65, 16384
    ds_read_b128 a[228:231], v4 offset:17408
    v_mfma_f32_16x16x32_bf16 v[148:151], a[212:215], a[152:155], v[148:151]
    s_add_u32 s47, s70, 245760
    ds_read_b128 a[232:235], v4 offset:18432
    v_mfma_f32_16x16x32_bf16 v[204:207], a[212:215], a[156:159], v[204:207]
    s_waitcnt lgkmcnt(3)
    buffer_load_dwordx4 v241, s[32:35], s47 offen sc1 lds
    v_mfma_f32_16x16x32_bf16 v[152:155], a[216:219], a[152:155], v[152:155]
    ds_read_b128 a[236:239], v4 offset:19456
    v_mfma_f32_16x16x32_bf16 v[208:211], a[216:219], a[156:159], v[208:211]
    ds_read_b128 a[240:243], v4 offset:20480
    v_mfma_f32_16x16x32_bf16 v[156:159], a[220:223], a[152:155], v[156:159]
    v_mfma_f32_16x16x32_bf16 v[212:215], a[220:223], a[156:159], v[212:215]
    s_waitcnt lgkmcnt(2)
    buffer_load_dwordx4 v241, s[32:35], s47 offen offset:1024 sc1 lds
    v_mfma_f32_16x16x32_bf16 v[160:163], a[224:227], a[0:3], 0
    ds_read_b128 a[244:247], v4 offset:21504
    v_mul_f32 v128, v128, v132
    v_mfma_f32_16x16x32_bf16 v[216:219], a[224:227], a[4:7], 0
    s_add_u32 m0, s65, 24576
    ds_read_b128 a[248:251], v4 offset:22528
    v_mul_f32 v129, v129, v133
    v_mfma_f32_16x16x32_bf16 v[164:167], a[228:231], a[0:3], 0
    s_add_u32 s47, s70, 253952
    v_mul_f32 v130, v130, v134
    v_mul_f32 v131, v131, v135
    v_mfma_f32_16x16x32_bf16 v[220:223], a[228:231], a[4:7], 0
    buffer_load_dwordx4 v242, s[32:35], s47 offen sc1 lds
    v_cvt_pk_bf16_f32 v40, v128, v129
    v_mfma_f32_16x16x32_bf16 v[168:171], a[232:235], a[0:3], 0
    ds_read_b128 a[252:255], v4 offset:23552
    v_cvt_pk_bf16_f32 v41, v130, v131
    v_mfma_f32_16x16x32_bf16 v[224:227], a[232:235], a[4:7], 0
    s_waitcnt lgkmcnt(2)
    ds_read_b128 a[208:211], v3 offset:16384
    v_mul_f32 v184, v184, v188
    v_mfma_f32_16x16x32_bf16 v[172:175], a[236:239], a[0:3], 0
    v_mul_f32 v185, v185, v189
    v_mul_f32 v186, v186, v190
    v_mfma_f32_16x16x32_bf16 v[228:231], a[236:239], a[4:7], 0
    buffer_load_dwordx4 v242, s[32:35], s47 offen offset:1024 sc1 lds
    v_mul_f32 v187, v187, v191
    v_mfma_f32_16x16x32_bf16 v[176:179], a[240:243], a[0:3], 0
    ds_read_b128 a[212:215], v3 offset:17408
    v_cvt_pk_bf16_f32 v48, v184, v185
    v_mfma_f32_16x16x32_bf16 v[232:235], a[240:243], a[4:7], 0
    ds_read_b128 a[216:219], v3 offset:18432
    v_cvt_pk_bf16_f32 v49, v186, v187
    v_mfma_f32_16x16x32_bf16 v[180:183], a[244:247], a[0:3], 0
    s_add_u32 m0, s65, 32768
    s_add_u32 s47, s70, 262144
    v_mul_f32 v136, v136, v140
    v_mfma_f32_16x16x32_bf16 v[236:239], a[244:247], a[4:7], 0
    s_waitcnt lgkmcnt(2)
    ds_read_b128 a[220:223], v3 offset:19456
    v_mul_f32 v137, v137, v141
    v_mfma_f32_16x16x32_bf16 v[160:163], a[248:251], a[8:11], v[160:163]
    buffer_load_dwordx4 v240, s[32:35], s47 offen sc1 lds
    v_mul_f32 v138, v138, v142
    v_mfma_f32_16x16x32_bf16 v[216:219], a[248:251], a[12:15], v[216:219]
    ds_read_b128 a[224:227], v3 offset:20480
    v_mul_f32 v139, v139, v143
    v_mfma_f32_16x16x32_bf16 v[164:167], a[252:255], a[8:11], v[164:167]
    v_cvt_pk_bf16_f32 v42, v136, v137
    v_cvt_pk_bf16_f32 v43, v138, v139
    v_mfma_f32_16x16x32_bf16 v[220:223], a[252:255], a[12:15], v[220:223]
    ds_read_b128 a[228:231], v3 offset:21504
    v_mul_f32 v192, v192, v196
    v_mfma_f32_16x16x32_bf16 v[168:171], a[208:211], a[8:11], v[168:171]
    buffer_load_dwordx4 v240, s[32:35], s47 offen offset:1024 sc1 lds
    v_mul_f32 v193, v193, v197
    v_mfma_f32_16x16x32_bf16 v[224:227], a[208:211], a[12:15], v[224:227]
    s_waitcnt lgkmcnt(2)
    ds_read_b128 a[232:235], v3 offset:22528
    v_mul_f32 v194, v194, v198
    v_mfma_f32_16x16x32_bf16 v[172:175], a[212:215], a[8:11], v[172:175]
    s_add_u32 m0, s65, 40960
    s_add_u32 s47, s70, 270336
    v_mul_f32 v195, v195, v199
    v_mfma_f32_16x16x32_bf16 v[228:231], a[212:215], a[12:15], v[228:231]
    ds_read_b128 a[236:239], v3 offset:23552
    v_cvt_pk_bf16_f32 v50, v192, v193
    v_mfma_f32_16x16x32_bf16 v[176:179], a[216:219], a[8:11], v[176:179]
    buffer_load_dwordx4 v241, s[32:35], s47 offen sc1 lds
    v_cvt_pk_bf16_f32 v51, v194, v195
    v_mfma_f32_16x16x32_bf16 v[232:235], a[216:219], a[12:15], v[232:235]
    s_waitcnt vmcnt(19)
    s_barrier
    v_mfma_f32_16x16x32_bf16 v[180:183], a[220:223], a[8:11], v[180:183]
    ds_read_b128 a[240:243], v3 offset:24576
    v_mul_f32 v144, v144, v148
    v_mfma_f32_16x16x32_bf16 v[236:239], a[220:223], a[12:15], v[236:239]
    s_waitcnt lgkmcnt(2)
    ds_read_b128 a[244:247], v3 offset:25600
    v_mul_f32 v145, v145, v149
    v_mfma_f32_16x16x32_bf16 v[160:163], a[224:227], a[16:19], v[160:163]
    buffer_load_dwordx4 v241, s[32:35], s47 offen offset:1024 sc1 lds
    v_mul_f32 v146, v146, v150
    v_mfma_f32_16x16x32_bf16 v[216:219], a[224:227], a[20:23], v[216:219]
    ds_read_b128 a[248:251], v3 offset:26624
    v_mul_f32 v147, v147, v151
    v_mfma_f32_16x16x32_bf16 v[164:167], a[228:231], a[16:19], v[164:167]
    v_cvt_pk_bf16_f32 v44, v144, v145
    v_cvt_pk_bf16_f32 v45, v146, v147
    v_mfma_f32_16x16x32_bf16 v[220:223], a[228:231], a[20:23], v[220:223]
    s_add_u32 m0, s65, 49152
    ds_read_b128 a[252:255], v3 offset:27648
    v_mul_f32 v200, v200, v204
    v_mfma_f32_16x16x32_bf16 v[168:171], a[232:235], a[16:19], v[168:171]
    s_add_u32 s47, s70, 278528
    v_mul_f32 v201, v201, v205
    v_mul_f32 v202, v202, v206
    v_mfma_f32_16x16x32_bf16 v[224:227], a[232:235], a[20:23], v[224:227]
    s_waitcnt lgkmcnt(2)
    buffer_load_dwordx4 v242, s[32:35], s47 offen sc1 lds
    v_mfma_f32_16x16x32_bf16 v[172:175], a[236:239], a[16:19], v[172:175]
    ds_read_b128 a[208:211], v3 offset:28672
    v_mul_f32 v203, v203, v207
    v_mfma_f32_16x16x32_bf16 v[228:231], a[236:239], a[20:23], v[228:231]
    ds_read_b128 a[212:215], v3 offset:29696
    v_cvt_pk_bf16_f32 v52, v200, v201
    v_mfma_f32_16x16x32_bf16 v[176:179], a[240:243], a[16:19], v[176:179]
    v_cvt_pk_bf16_f32 v53, v202, v203
    v_mul_f32 v152, v152, v156
    v_mfma_f32_16x16x32_bf16 v[232:235], a[240:243], a[20:23], v[232:235]
    buffer_load_dwordx4 v242, s[32:35], s47 offen offset:1024 sc1 lds
    v_mul_f32 v153, v153, v157
    v_mfma_f32_16x16x32_bf16 v[180:183], a[244:247], a[16:19], v[180:183]
    ds_read_b128 a[216:219], v3 offset:30720
    v_mul_f32 v154, v154, v158
    v_mfma_f32_16x16x32_bf16 v[236:239], a[244:247], a[20:23], v[236:239]
    s_waitcnt lgkmcnt(2)
    ds_read_b128 a[220:223], v3 offset:31744
    v_mul_f32 v155, v155, v159
    v_mfma_f32_16x16x32_bf16 v[160:163], a[248:251], a[24:27], v[160:163]
    s_add_u32 m0, s65, 57344
    s_add_u32 s47, s71, 0
    v_cvt_pk_bf16_f32 v46, v152, v153
    v_mfma_f32_16x16x32_bf16 v[216:219], a[248:251], a[28:31], v[216:219]
    buffer_load_dwordx4 v2, s[32:35], s47 offen sc1 lds
    v_cvt_pk_bf16_f32 v47, v154, v155
    v_mfma_f32_16x16x32_bf16 v[164:167], a[252:255], a[24:27], v[164:167]
    ds_read_b128 a[224:227], v3 offset:32768
    v_mul_f32 v208, v208, v212
    v_mfma_f32_16x16x32_bf16 v[220:223], a[252:255], a[28:31], v[220:223]
    ds_read_b128 a[228:231], v3 offset:33792
    v_mul_f32 v209, v209, v213
    v_mfma_f32_16x16x32_bf16 v[168:171], a[208:211], a[24:27], v[168:171]
    v_mul_f32 v210, v210, v214
    v_mul_f32 v211, v211, v215
    v_mfma_f32_16x16x32_bf16 v[224:227], a[208:211], a[28:31], v[224:227]
    s_waitcnt lgkmcnt(2)
    buffer_load_dwordx4 v2, s[32:35], s47 offen offset:1024 sc1 lds
    v_mfma_f32_16x16x32_bf16 v[172:175], a[212:215], a[24:27], v[172:175]
    ds_read_b128 a[232:235], v3 offset:34816
    v_cvt_pk_bf16_f32 v54, v208, v209
    v_mfma_f32_16x16x32_bf16 v[228:231], a[212:215], a[28:31], v[228:231]
    ds_read_b128 a[236:239], v3 offset:35840
    v_cvt_pk_bf16_f32 v55, v210, v211
    v_mfma_f32_16x16x32_bf16 v[176:179], a[216:219], a[24:27], v[176:179]
    v_fmac_f32 v160, v64, v244
    v_fmac_f32 v216, v64, v248
    v_mfma_f32_16x16x32_bf16 v[232:235], a[216:219], a[28:31], v[232:235]
    ds_read_b128 a[240:243], v3 offset:36864
    v_fmac_f32 v164, v72, v244
    v_mfma_f32_16x16x32_bf16 v[180:183], a[220:223], a[24:27], v[180:183]
    buffer_store_dwordx4 v[40:43], v2, s[32:35], s83 offen offset:0 sc1
    v_mfma_f32_16x16x32_bf16 v[236:239], a[220:223], a[28:31], v[236:239]
    s_waitcnt lgkmcnt(2)
    ds_read_b128 a[244:247], v3 offset:37888
    v_fmac_f32 v220, v72, v248
    v_mfma_f32_16x16x32_bf16 v[160:163], a[224:227], a[32:35], v[160:163]
    v_fmac_f32 v168, v80, v244
    v_fmac_f32 v224, v80, v248
    v_mfma_f32_16x16x32_bf16 v[216:219], a[224:227], a[36:39], v[216:219]
    ds_read_b128 a[248:251], v3 offset:38912
    v_fmac_f32 v172, v88, v244
    v_mfma_f32_16x16x32_bf16 v[164:167], a[228:231], a[32:35], v[164:167]
    v_fmac_f32 v228, v88, v248
    v_fmac_f32 v176, v96, v244
    v_mfma_f32_16x16x32_bf16 v[220:223], a[228:231], a[36:39], v[220:223]
    ds_read_b128 a[252:255], v3 offset:39936
    v_fmac_f32 v232, v96, v248
    v_mfma_f32_16x16x32_bf16 v[168:171], a[232:235], a[32:35], v[168:171]
    v_fmac_f32 v180, v104, v244
    v_fmac_f32 v236, v104, v248
    v_mfma_f32_16x16x32_bf16 v[224:227], a[232:235], a[36:39], v[224:227]
    s_waitcnt lgkmcnt(2)
    buffer_store_dwordx4 v[44:47], v2, s[32:35], s83 offen offset:1024 sc1
    v_mfma_f32_16x16x32_bf16 v[172:175], a[236:239], a[32:35], v[172:175]
    s_waitcnt vmcnt(22)
    s_barrier
    v_mfma_f32_16x16x32_bf16 v[228:231], a[236:239], a[36:39], v[228:231]
    ds_read_b128 a[208:211], v3 offset:40960
    v_fmac_f32 v161, v65, v244
    v_mfma_f32_16x16x32_bf16 v[176:179], a[240:243], a[32:35], v[176:179]
    ds_read_b128 a[212:215], v3 offset:41984
    v_fmac_f32 v217, v65, v248
    v_mfma_f32_16x16x32_bf16 v[232:235], a[240:243], a[36:39], v[232:235]
    ds_read_b128 a[216:219], v3 offset:43008
    v_fmac_f32 v165, v73, v244
    v_mfma_f32_16x16x32_bf16 v[180:183], a[244:247], a[32:35], v[180:183]
    v_fmac_f32 v221, v73, v248
    v_fmac_f32 v169, v81, v244
    v_mfma_f32_16x16x32_bf16 v[236:239], a[244:247], a[36:39], v[236:239]
    s_waitcnt lgkmcnt(3)
    buffer_store_dwordx4 v[48:51], v2, s[32:35], s84 offen offset:0 sc1
    v_mfma_f32_16x16x32_bf16 v[160:163], a[248:251], a[40:43], v[160:163]
    ds_read_b128 a[220:223], v3 offset:44032
    v_fmac_f32 v225, v81, v248
    v_mfma_f32_16x16x32_bf16 v[216:219], a[248:251], a[44:47], v[216:219]
    ds_read_b128 a[224:227], v3 offset:45056
    v_fmac_f32 v173, v89, v244
    v_mfma_f32_16x16x32_bf16 v[164:167], a[252:255], a[40:43], v[164:167]
    v_fmac_f32 v229, v89, v248
    v_fmac_f32 v177, v97, v244
    v_mfma_f32_16x16x32_bf16 v[220:223], a[252:255], a[44:47], v[220:223]
    s_waitcnt lgkmcnt(2)
    ds_read_b128 a[228:231], v3 offset:46080
    v_fmac_f32 v233, v97, v248
    v_mfma_f32_16x16x32_bf16 v[168:171], a[208:211], a[40:43], v[168:171]
    v_fmac_f32 v181, v105, v244
    v_fmac_f32 v237, v105, v248
    v_mfma_f32_16x16x32_bf16 v[224:227], a[208:211], a[44:47], v[224:227]
    ds_read_b128 a[232:235], v3 offset:47104
    v_fmac_f32 v162, v66, v244
    v_mfma_f32_16x16x32_bf16 v[172:175], a[212:215], a[40:43], v[172:175]
    buffer_store_dwordx4 v[52:55], v2, s[32:35], s84 offen offset:1024 sc1
    v_mfma_f32_16x16x32_bf16 v[228:231], a[212:215], a[44:47], v[228:231]
    ds_read_b128 a[236:239], v3 offset:48128
    v_fmac_f32 v218, v66, v248
    v_mfma_f32_16x16x32_bf16 v[176:179], a[216:219], a[40:43], v[176:179]
    v_fmac_f32 v166, v74, v244
    v_fmac_f32 v222, v74, v248
    v_mfma_f32_16x16x32_bf16 v[232:235], a[216:219], a[44:47], v[232:235]
    s_waitcnt lgkmcnt(2)
    ds_read_b128 a[240:243], v3 offset:49152
    v_fmac_f32 v170, v82, v244
    v_mfma_f32_16x16x32_bf16 v[180:183], a[220:223], a[40:43], v[180:183]
    v_fmac_f32 v226, v82, v248
    v_fmac_f32 v174, v90, v244
    v_mfma_f32_16x16x32_bf16 v[236:239], a[220:223], a[44:47], v[236:239]
    s_add_u32 m0, s65, 65536
    ds_read_b128 a[244:247], v3 offset:50176
    v_fmac_f32 v230, v90, v248
    v_mfma_f32_16x16x32_bf16 v[160:163], a[224:227], a[48:51], v[160:163]
    s_add_u32 s47, s71, 8192
    v_fmac_f32 v178, v98, v244
    v_fmac_f32 v234, v98, v248
    v_mfma_f32_16x16x32_bf16 v[216:219], a[224:227], a[52:55], v[216:219]
    buffer_load_dwordx4 v2, s[32:35], s47 offen sc1 lds
    v_fmac_f32 v182, v106, v244
    v_mfma_f32_16x16x32_bf16 v[164:167], a[228:231], a[48:51], v[164:167]
    ds_read_b128 a[248:251], v3 offset:51200
    v_fmac_f32 v238, v106, v248
    v_mfma_f32_16x16x32_bf16 v[220:223], a[228:231], a[52:55], v[220:223]
    s_waitcnt lgkmcnt(2)
    ds_read_b128 a[252:255], v3 offset:52224
    v_fmac_f32 v163, v67, v244
    v_mfma_f32_16x16x32_bf16 v[168:171], a[232:235], a[48:51], v[168:171]
    v_fmac_f32 v219, v67, v248
    v_fmac_f32 v167, v75, v244
    v_mfma_f32_16x16x32_bf16 v[224:227], a[232:235], a[52:55], v[224:227]
    buffer_load_dwordx4 v2, s[32:35], s47 offen offset:1024 sc1 lds
    v_fmac_f32 v223, v75, v248
    v_mfma_f32_16x16x32_bf16 v[172:175], a[236:239], a[48:51], v[172:175]
    ds_read_b128 a[208:211], v3 offset:53248
    v_fmac_f32 v235, v99, v248
    v_mfma_f32_16x16x32_bf16 v[228:231], a[236:239], a[52:55], v[228:231]
    ds_read_b128 a[212:215], v3 offset:54272
    v_fmac_f32 v171, v83, v244
    v_mfma_f32_16x16x32_bf16 v[176:179], a[240:243], a[48:51], v[176:179]
    s_add_u32 m0, s65, 73728
    s_add_u32 s47, s71, 16384
    v_fmac_f32 v227, v83, v248
    v_mfma_f32_16x16x32_bf16 v[232:235], a[240:243], a[52:55], v[232:235]
    s_waitcnt lgkmcnt(2)
    ds_read_b128 a[216:219], v3 offset:55296
    v_fmac_f32 v175, v91, v244
    v_mfma_f32_16x16x32_bf16 v[180:183], a[244:247], a[48:51], v[180:183]
    buffer_load_dwordx4 v2, s[32:35], s47 offen sc1 lds
    v_fmac_f32 v231, v91, v248
    v_mfma_f32_16x16x32_bf16 v[236:239], a[244:247], a[52:55], v[236:239]
    ds_read_b128 a[220:223], v3 offset:56320
    v_fmac_f32 v179, v99, v244
    v_mfma_f32_16x16x32_bf16 v[160:163], a[248:251], a[56:59], v[160:163]
    v_fmac_f32 v220, v76, v249
    v_fmac_f32 v168, v84, v245
    v_mfma_f32_16x16x32_bf16 v[216:219], a[248:251], a[60:63], v[216:219]
    s_waitcnt vmcnt(23)
    s_barrier
    v_mfma_f32_16x16x32_bf16 v[164:167], a[252:255], a[56:59], v[164:167]
    buffer_load_dwordx4 v2, s[32:35], s47 offen offset:1024 sc1 lds
    v_fmac_f32 v183, v107, v244
    v_mfma_f32_16x16x32_bf16 v[220:223], a[252:255], a[60:63], v[220:223]
    s_waitcnt lgkmcnt(1)
    ds_read_b128 a[224:227], v3 offset:57344
    v_fmac_f32 v239, v107, v248
    v_mfma_f32_16x16x32_bf16 v[168:171], a[208:211], a[56:59], v[168:171]
    s_add_u32 m0, s65, 139264
    ds_read_b128 a[228:231], v3 offset:58368
    v_fmac_f32 v160, v68, v245
    v_mfma_f32_16x16x32_bf16 v[224:227], a[208:211], a[60:63], v[224:227]
    s_add_u32 s47, s71, 24576
    ds_read_b128 a[232:235], v3 offset:59392
    v_fmac_f32 v216, v68, v249
    v_mfma_f32_16x16x32_bf16 v[172:175], a[212:215], a[56:59], v[172:175]
    buffer_load_dwordx4 v2, s[32:35], s47 offen sc1 lds
    v_fmac_f32 v164, v76, v245
    v_mfma_f32_16x16x32_bf16 v[228:231], a[212:215], a[60:63], v[228:231]
    ds_read_b128 a[236:239], v3 offset:60416
    v_fmac_f32 v224, v84, v249
    v_mfma_f32_16x16x32_bf16 v[176:179], a[216:219], a[56:59], v[176:179]
    v_fmac_f32 v236, v108, v249
    v_fmac_f32 v161, v69, v245
    v_mfma_f32_16x16x32_bf16 v[232:235], a[216:219], a[60:63], v[232:235]
    s_waitcnt lgkmcnt(2)
    ds_read_b128 a[240:243], v3 offset:61440
    v_fmac_f32 v172, v92, v245
    v_mfma_f32_16x16x32_bf16 v[180:183], a[220:223], a[56:59], v[180:183]
    buffer_load_dwordx4 v2, s[32:35], s47 offen offset:1024 sc1 lds
    v_fmac_f32 v228, v92, v249
    v_mfma_f32_16x16x32_bf16 v[236:239], a[220:223], a[60:63], v[236:239]
    ds_read_b128 a[244:247], v3 offset:62464
    v_fmac_f32 v176, v100, v245
    v_mfma_f32_16x16x32_bf16 v[160:163], a[224:227], a[64:67], v[160:163]
    v_fmac_f32 v232, v100, v249
    v_fmac_f32 v221, v77, v249
    v_mfma_f32_16x16x32_bf16 v[216:219], a[224:227], a[68:71], v[216:219]
    s_add_u32 m0, s65, 147456
    ds_read_b128 a[248:251], v3 offset:63488
    v_fmac_f32 v180, v108, v245
    v_mfma_f32_16x16x32_bf16 v[164:167], a[228:231], a[64:67], v[164:167]
    s_add_u32 s47, s71, 32768
    v_fmac_f32 v225, v85, v249
    v_fmac_f32 v173, v93, v245
    v_mfma_f32_16x16x32_bf16 v[220:223], a[228:231], a[68:71], v[220:223]
    s_waitcnt lgkmcnt(2)
    buffer_load_dwordx4 v2, s[32:35], s47 offen sc1 lds
    v_mfma_f32_16x16x32_bf16 v[168:171], a[232:235], a[64:67], v[168:171]
    ds_read_b128 a[252:255], v3 offset:64512
    v_fmac_f32 v217, v69, v249
    v_mfma_f32_16x16x32_bf16 v[224:227], a[232:235], a[68:71], v[224:227]
    ds_read_b128 a[208:211], v4 offset:0
    v_fmac_f32 v165, v77, v245
    v_mfma_f32_16x16x32_bf16 v[172:175], a[236:239], a[64:67], v[172:175]
    v_fmac_f32 v233, v101, v249
    v_fmac_f32 v181, v109, v245
    v_mfma_f32_16x16x32_bf16 v[228:231], a[236:239], a[68:71], v[228:231]
    buffer_load_dwordx4 v2, s[32:35], s47 offen offset:1024 sc1 lds
    v_fmac_f32 v169, v85, v245
    v_mfma_f32_16x16x32_bf16 v[176:179], a[240:243], a[64:67], v[176:179]
    ds_read_b128 a[212:215], v4 offset:1024
    v_fmac_f32 v237, v109, v249
    v_mfma_f32_16x16x32_bf16 v[232:235], a[240:243], a[68:71], v[232:235]
    s_waitcnt lgkmcnt(2)
    ds_read_b128 a[216:219], v4 offset:2048
    v_fmac_f32 v229, v93, v249
    v_mfma_f32_16x16x32_bf16 v[180:183], a[244:247], a[64:67], v[180:183]
    s_add_u32 m0, s65, 81920
    s_add_u32 s47, s71, 40960
    v_fmac_f32 v177, v101, v245
    v_mfma_f32_16x16x32_bf16 v[236:239], a[244:247], a[68:71], v[236:239]
    buffer_load_dwordx4 v2, s[32:35], s47 offen sc1 lds
    v_fmac_f32 v166, v78, v245
    v_mfma_f32_16x16x32_bf16 v[160:163], a[248:251], a[72:75], v[160:163]
    ds_read_b128 a[220:223], v4 offset:3072
    v_fmac_f32 v222, v78, v249
    v_mfma_f32_16x16x32_bf16 v[216:219], a[248:251], a[76:79], v[216:219]
    s_waitcnt vmcnt(9)
    ds_read_b128 a[224:227], v4 offset:4096
    v_fmac_f32 v170, v86, v245
    v_mfma_f32_16x16x32_bf16 v[164:167], a[252:255], a[72:75], v[164:167]
    v_add_u32 v22, 1, v22
    s_add_u32 s67, s46, 65536
    v_fmac_f32 v162, v70, v245
    v_mfma_f32_16x16x32_bf16 v[220:223], a[252:255], a[76:79], v[220:223]
    s_waitcnt lgkmcnt(2)
    buffer_store_dword v22, v60, s[32:35], s67 offen sc1
    v_mfma_f32_16x16x32_bf16 v[168:171], a[208:211], a[72:75], v[168:171]
    ds_read_b128 a[228:231], v4 offset:5120
    v_fmac_f32 v218, v70, v249
    v_mfma_f32_16x16x32_bf16 v[224:227], a[208:211], a[76:79], v[224:227]
    buffer_load_dwordx4 v2, s[32:35], s47 offen offset:1024 sc1 lds
    v_fmac_f32 v178, v102, v245
    v_mfma_f32_16x16x32_bf16 v[172:175], a[212:215], a[72:75], v[172:175]
    ds_read_b128 a[232:235], v4 offset:6144
    v_fmac_f32 v234, v102, v249
    v_mfma_f32_16x16x32_bf16 v[228:231], a[212:215], a[76:79], v[228:231]
    s_add_u32 m0, s65, 90112
    ds_read_b128 a[236:239], v4 offset:7168
    v_fmac_f32 v226, v86, v249
    v_mfma_f32_16x16x32_bf16 v[176:179], a[216:219], a[72:75], v[176:179]
    s_add_u32 s47, s71, 49152
    v_fmac_f32 v174, v94, v245
    v_fmac_f32 v238, v110, v249
    v_mfma_f32_16x16x32_bf16 v[232:235], a[216:219], a[76:79], v[232:235]
    s_waitcnt lgkmcnt(2)
    buffer_load_dwordx4 v2, s[32:35], s47 offen sc1 lds
    v_mfma_f32_16x16x32_bf16 v[180:183], a[220:223], a[72:75], v[180:183]
    s_barrier
    v_mfma_f32_16x16x32_bf16 v[236:239], a[220:223], a[76:79], v[236:239]
    ds_read_b128 a[240:243], v2 offset:0
    v_fmac_f32 v230, v94, v249
    v_mfma_f32_16x16x32_bf16 v[160:163], a[224:227], a[80:83], v[160:163]
    ds_read_b128 a[244:247], v2 offset:1024
    v_fmac_f32 v223, v79, v249
    v_mfma_f32_16x16x32_bf16 v[216:219], a[224:227], a[84:87], v[216:219]
    buffer_load_dwordx4 v2, s[32:35], s47 offen offset:1024 sc1 lds
    v_fmac_f32 v182, v110, v245
    v_mfma_f32_16x16x32_bf16 v[164:167], a[228:231], a[80:83], v[164:167]
    ds_read_b128 a[248:251], v2 offset:2048
    v_fmac_f32 v227, v87, v249
    v_mfma_f32_16x16x32_bf16 v[220:223], a[228:231], a[84:87], v[220:223]
    s_waitcnt lgkmcnt(3)
    ds_read_b128 a[252:255], v2 offset:3072
    v_fmac_f32 v163, v71, v245
    v_mfma_f32_16x16x32_bf16 v[168:171], a[232:235], a[80:83], v[168:171]
    s_add_u32 m0, s65, 98304
    s_add_u32 s47, s71, 57344
    v_fmac_f32 v219, v71, v249
    v_mfma_f32_16x16x32_bf16 v[224:227], a[232:235], a[84:87], v[224:227]
    ds_read_b128 a[208:211], v2 offset:4096
    v_fmac_f32 v167, v79, v245
    v_mfma_f32_16x16x32_bf16 v[172:175], a[236:239], a[80:83], v[172:175]
    buffer_load_dwordx4 v2, s[32:35], s47 offen sc1 lds
    v_fmac_f32 v171, v87, v245
    v_mfma_f32_16x16x32_bf16 v[228:231], a[236:239], a[84:87], v[228:231]
    s_waitcnt lgkmcnt(2)
    ds_read_b128 a[212:215], v2 offset:5120
    v_fmac_f32 v183, v111, v245
    v_mfma_f32_16x16x32_bf16 v[176:179], a[240:243], a[80:83], v[176:179]
    v_fmac_f32 v239, v111, v249
    v_fmac_f32 v175, v95, v245
    v_mfma_f32_16x16x32_bf16 v[232:235], a[240:243], a[84:87], v[232:235]
    ds_read_b128 a[216:219], v2 offset:6144
    v_fmac_f32 v231, v95, v249
    v_mfma_f32_16x16x32_bf16 v[180:183], a[244:247], a[80:83], v[180:183]
    buffer_load_dwordx4 v2, s[32:35], s47 offen offset:1024 sc1 lds
L_pad6:
    s_cbranch_execz L_hopped
    v_mfma_f32_16x16x32_bf16 v[236:239], a[244:247], a[84:87], v[236:239]
    ds_read_b128 a[220:223], v2 offset:7168
    v_fmac_f32 v179, v103, v245
    v_mfma_f32_16x16x32_bf16 v[160:163], a[248:251], a[88:91], v[160:163]
    s_add_u32 m0, s65, 106496
    s_add_u32 s47, s71, 65536
    v_fmac_f32 v235, v103, v249
    v_mfma_f32_16x16x32_bf16 v[216:219], a[248:251], a[92:95], v[216:219]
    s_waitcnt lgkmcnt(2)
    ds_read_b128 a[224:227], v2 offset:8192
    v_mfma_f32_16x16x32_bf16 v[164:167], a[252:255], a[88:91], v[164:167]
    s_and_b32 s79, s62, 8
    buffer_load_dwordx4 v2, s[32:35], s47 offen sc1 lds
    v_mfma_f32_16x16x32_bf16 v[220:223], a[252:255], a[92:95], v[220:223]
    s_add_u32 s79, s79, s62
    ds_read_b128 a[228:231], v2 offset:9216
    v_mfma_f32_16x16x32_bf16 v[168:171], a[208:211], a[88:91], v[168:171]
    s_lshl_b32 s79, s79, 10
    s_add_u32 s79, s79, s82
    v_mfma_f32_16x16x32_bf16 v[224:227], a[208:211], a[92:95], v[224:227]
    s_add_u32 s80, s79, 180224
    ds_read_b128 a[232:235], v2 offset:10240
    v_mfma_f32_16x16x32_bf16 v[172:175], a[212:215], a[88:91], v[172:175]
    s_add_u32 s79, s79, 65536
    buffer_load_dwordx4 v2, s[32:35], s47 offen offset:1024 sc1 lds
    v_mfma_f32_16x16x32_bf16 v[228:231], a[212:215], a[92:95], v[228:231]
    s_waitcnt lgkmcnt(2)
    ds_read_b128 a[236:239], v2 offset:11264
    v_mfma_f32_16x16x32_bf16 v[176:179], a[216:219], a[88:91], v[176:179]
    s_lshr_b32 s81, s62, 3
    s_mul_i32 s81, s81, 6
    v_mfma_f32_16x16x32_bf16 v[232:235], a[216:219], a[92:95], v[232:235]
    s_add_u32 m0, s65, 114688
    ds_read_b128 a[240:243], v2 offset:12288
    v_mfma_f32_16x16x32_bf16 v[180:183], a[220:223], a[88:91], v[180:183]
    s_add_u32 s47, s71, 73728
    s_add_u32 s81, s81, s74
    v_mfma_f32_16x16x32_bf16 v[236:239], a[220:223], a[92:95], v[236:239]
    s_lshl_b32 s81, s81, 9
    buffer_load_dwordx4 v2, s[32:35], s47 offen sc1 lds
    v_mfma_f32_16x16x32_bf16 v[160:163], a[224:227], a[96:99], v[160:163]
    s_add_u32 s81, s81, s82
    ds_read_b128 a[244:247], v2 offset:13312
    v_mfma_f32_16x16x32_bf16 v[216:219], a[224:227], a[100:103], v[216:219]
    s_waitcnt lgkmcnt(2)
    ds_read_b128 a[248:251], v2 offset:14336
    v_mfma_f32_16x16x32_bf16 v[164:167], a[228:231], a[96:99], v[164:167]
    s_add_u32 s81, s81, 98304
    s_cmp_ge_u32 s74, 6
    s_cselect_b32 s81, 1073741824, s81
    v_mfma_f32_16x16x32_bf16 v[220:223], a[228:231], a[100:103], v[220:223]
    buffer_load_dwordx4 v2, s[32:35], s47 offen offset:1024 sc1 lds
    v_lshrrev_b32 v25, 5, v1
    v_mfma_f32_16x16x32_bf16 v[168:171], a[232:235], a[96:99], v[168:171]
    ds_read_b128 a[252:255], v2 offset:15360
    v_mul_u32_u24 v25, 114176, v25
    v_mfma_f32_16x16x32_bf16 v[224:227], a[232:235], a[100:103], v[224:227]
    s_barrier
    v_mfma_f32_16x16x32_bf16 v[172:175], a[236:239], a[96:99], v[172:175]
    s_add_u32 s3, s46, 65536
    ds_read_b128 a[208:211], v2 offset:16384
    v_add_u32 v25, v25, v2
    v_mfma_f32_16x16x32_bf16 v[228:231], a[236:239], a[100:103], v[228:231]
    s_waitcnt lgkmcnt(2)
    buffer_load_dword v24, v243, s[32:35], s3 offen sc1
    v_mfma_f32_16x16x32_bf16 v[176:179], a[240:243], a[96:99], v[176:179]
    s_add_u32 m0, s65, 122880
    ds_read_b128 a[212:215], v2 offset:17408
    v_mfma_f32_16x16x32_bf16 v[232:235], a[240:243], a[100:103], v[232:235]
    s_add_u32 s47, s71, 81920
    ds_read_b128 a[216:219], v2 offset:18432
    v_mfma_f32_16x16x32_bf16 v[180:183], a[244:247], a[96:99], v[180:183]
    buffer_load_dwordx4 v2, s[32:35], s47 offen sc1 lds
    v_mfma_f32_16x16x32_bf16 v[236:239], a[244:247], a[100:103], v[236:239]
    ds_read_b128 a[220:223], v2 offset:19456
    v_mfma_f32_16x16x32_bf16 v[160:163], a[248:251], a[104:107], v[160:163]
    v_mfma_f32_16x16x32_bf16 v[216:219], a[248:251], a[108:111], v[216:219]
    s_waitcnt lgkmcnt(2)
    ds_read_b128 a[224:227], v2 offset:20480
    v_mfma_f32_16x16x32_bf16 v[164:167], a[252:255], a[104:107], v[164:167]
    buffer_load_dwordx4 v2, s[32:35], s47 offen offset:1024 sc1 lds
    v_mfma_f32_16x16x32_bf16 v[220:223], a[252:255], a[108:111], v[220:223]
    ds_read_b128 a[228:231], v2 offset:21504
    v_mfma_f32_16x16x32_bf16 v[168:171], a[208:211], a[104:107], v[168:171]
    s_add_u32 m0, s65, 131072
    s_add_u32 s47, s71, 90112
    v_mfma_f32_16x16x32_bf16 v[224:227], a[208:211], a[108:111], v[224:227]
    ds_read_b128 a[232:235], v2 offset:22528
    v_mfma_f32_16x16x32_bf16 v[172:175], a[212:215], a[104:107], v[172:175]
    buffer_load_dwordx4 v2, s[32:35], s47 offen sc1 lds
    v_mfma_f32_16x16x32_bf16 v[228:231], a[212:215], a[108:111], v[228:231]
    s_waitcnt lgkmcnt(2)
    ds_read_b128 a[236:239], v2 offset:23552
    v_mfma_f32_16x16x32_bf16 v[176:179], a[216:219], a[104:107], v[176:179]
    v_mfma_f32_16x16x32_bf16 v[232:235], a[216:219], a[108:111], v[232:235]
    ds_read_b128 a[240:243], v2 offset:24576
    v_mfma_f32_16x16x32_bf16 v[180:183], a[220:223], a[104:107], v[180:183]
    buffer_load_dwordx4 v2, s[32:35], s47 offen offset:1024 sc1 lds
    v_mfma_f32_16x16x32_bf16 v[236:239], a[220:223], a[108:111], v[236:239]
    ds_read_b128 a[244:247], v2 offset:25600
    v_mfma_f32_16x16x32_bf16 v[160:163], a[224:227], a[112:115], v[160:163]
    s_add_u32 m0, s65, 0
    s_add_u32 s47, s71, 98304
    v_mfma_f32_16x16x32_bf16 v[216:219], a[224:227], a[116:119], v[216:219]
    s_waitcnt lgkmcnt(2)
    ds_read_b128 a[248:251], v2 offset:26624
    v_mfma_f32_16x16x32_bf16 v[164:167], a[228:231], a[112:115], v[164:167]
    buffer_load_dwordx4 v2, s[32:35], s47 offen sc1 lds
    v_mfma_f32_16x16x32_bf16 v[220:223], a[228:231], a[116:119], v[220:223]
    ds_read_b128 a[252:255], v2 offset:27648
    v_mfma_f32_16x16x32_bf16 v[168:171], a[232:235], a[112:115], v[168:171]
    v_mfma_f32_16x16x32_bf16 v[224:227], a[232:235], a[116:119], v[224:227]
    ds_read_b128 a[208:211], v2 offset:28672
    v_mfma_f32_16x16x32_bf16 v[172:175], a[236:239], a[112:115], v[172:175]
    v_mfma_f32_16x16x32_bf16 v[228:231], a[236:239], a[116:119], v[228:231]
    s_waitcnt lgkmcnt(2)
    buffer_load_dwordx4 v2, s[32:35], s47 offen offset:1024 sc1 lds
    v_mfma_f32_16x16x32_bf16 v[176:179], a[240:243], a[112:115], v[176:179]
    ds_read_b128 a[212:215], v2 offset:29696
    v_mfma_f32_16x16x32_bf16 v[232:235], a[240:243], a[116:119], v[232:235]
    ds_read_b128 a[216:219], v2 offset:30720
    v_mfma_f32_16x16x32_bf16 v[180:183], a[244:247], a[112:115], v[180:183]
    v_mfma_f32_16x16x32_bf16 v[236:239], a[244:247], a[116:119], v[236:239]
    s_waitcnt vmcnt(6)
    v_subrev_u32 v24, s64, v24
    v_subrev_u32 v24, 3, v24
    v_cmp_lt_u32 vcc, 7, v24
    s_nop 0
    s_cbranch_vccz L_probed_34
    s_mov_b32 s67, 0
L_poll_35:
    s_add_u32 s76, s46, 65536
    buffer_load_dword v24, v243, s[32:35], s76 offen sc1
    s_waitcnt vmcnt(0)
    v_subrev_u32 v24, s64, v24
    v_subrev_u32 v24, 3, v24
    v_cmp_lt_u32 vcc, 7, v24
    s_nop 0
    s_cbranch_vccz L_ready_36
    s_add_u32 s67, s67, 1
    s_cmp_lt_u32 s67, 20000
    s_cbranch_scc1 L_poll_35
L_ready_36:
L_probed_34:
    v_mfma_f32_16x16x32_bf16 v[160:163], a[248:251], a[120:123], v[160:163]
    s_add_u32 s78, s85, 1179648
    ds_read_b128 a[220:223], v2 offset:31744
    v_mfma_f32_16x16x32_bf16 v[216:219], a[248:251], a[124:127], v[216:219]
    s_waitcnt lgkmcnt(2)
    buffer_load_dwordx4 a[160:163], v2, s[32:35], s78 offen offset:0 sc1
    v_mfma_f32_16x16x32_bf16 v[164:167], a[252:255], a[120:123], v[164:167]
    s_barrier
    v_mfma_f32_16x16x32_bf16 v[220:223], a[252:255], a[124:127], v[220:223]
    ds_read_b128 a[224:227], v2 offset:32768
    v_mfma_f32_16x16x32_bf16 v[168:171], a[208:211], a[120:123], v[168:171]
    ds_read_b128 a[228:231], v2 offset:33792
    v_mfma_f32_16x16x32_bf16 v[224:227], a[208:211], a[124:127], v[224:227]
    buffer_load_dwordx4 a[164:167], v2, s[32:35], s78 offen offset:1024 sc1
    v_mfma_f32_16x16x32_bf16 v[172:175], a[212:215], a[120:123], v[172:175]
    ds_read_b128 a[232:235], v2 offset:34816
    v_mfma_f32_16x16x32_bf16 v[228:231], a[212:215], a[124:127], v[228:231]
    s_waitcnt lgkmcnt(3)
    ds_read_b128 a[236:239], v2 offset:35840
    v_mfma_f32_16x16x32_bf16 v[176:179], a[216:219], a[120:123], v[176:179]
    v_mfma_f32_16x16x32_bf16 v[232:235], a[216:219], a[124:127], v[232:235]
    buffer_load_dwordx4 a[168:171], v2, s[32:35], s78 offen offset:2048 sc1
    v_mfma_f32_16x16x32_bf16 v[180:183], a[220:223], a[120:123], v[180:183]
    ds_read_b128 a[240:243], v2 offset:36864
    v_mfma_f32_16x16x32_bf16 v[236:239], a[220:223], a[124:127], v[236:239]
    s_waitcnt lgkmcnt(2)
    ds_read_b128 a[244:247], v2 offset:37888
    v_mfma_f32_16x16x32_bf16 v[160:163], a[224:227], a[128:131], v[160:163]
    v_mfma_f32_16x16x32_bf16 v[216:219], a[224:227], a[132:135], v[216:219]
    buffer_load_dwordx4 a[172:175], v2, s[32:35], s78 offen offset:3072 sc1
    v_mfma_f32_16x16x32_bf16 v[164:167], a[228:231], a[128:131], v[164:167]
    ds_read_b128 a[248:251], v2 offset:38912
    v_mfma_f32_16x16x32_bf16 v[220:223], a[228:231], a[132:135], v[220:223]
    s_add_u32 s78, s85, 1183744
    ds_read_b128 a[252:255], v2 offset:39936
    v_mfma_f32_16x16x32_bf16 v[168:171], a[232:235], a[128:131], v[168:171]
    v_mfma_f32_16x16x32_bf16 v[224:227], a[232:235], a[132:135], v[224:227]
    s_waitcnt lgkmcnt(2)
    buffer_load_dwordx4 a[176:179], v2, s[32:35], s78 offen offset:0 sc1
    v_mfma_f32_16x16x32_bf16 v[172:175], a[236:239], a[128:131], v[172:175]
    ds_read_b128 a[208:211], v2 offset:40960
    v_mfma_f32_16x16x32_bf16 v[228:231], a[236:239], a[132:135], v[228:231]
    ds_read_b128 a[212:215], v2 offset:41984
    v_mfma_f32_16x16x32_bf16 v[176:179], a[240:243], a[128:131], v[176:179]
    v_mfma_f32_16x16x32_bf16 v[232:235], a[240:243], a[132:135], v[232:235]
    ds_read_b128 a[216:219], v2 offset:43008
    v_mfma_f32_16x16x32_bf16 v[180:183], a[244:247], a[128:131], v[180:183]
    buffer_load_dwordx4 a[180:183], v2, s[32:35], s78 offen offset:1024 sc1
    v_mfma_f32_16x16x32_bf16 v[236:239], a[244:247], a[132:135], v[236:239]
    s_waitcnt lgkmcnt(2)
    ds_read_b128 a[220:223], v2 offset:44032
    v_mfma_f32_16x16x32_bf16 v[160:163], a[248:251], a[136:139], v[160:163]
    v_mfma_f32_16x16x32_bf16 v[216:219], a[248:251], a[140:143], v[216:219]
    ds_read_b128 a[224:227], v2 offset:45056
    v_mfma_f32_16x16x32_bf16 v[164:167], a[252:255], a[136:139], v[164:167]
    buffer_load_dwordx4 a[184:187], v2, s[32:35], s78 offen offset:2048 sc1
    v_mfma_f32_16x16x32_bf16 v[220:223], a[252:255], a[140:143], v[220:223]
    ds_read_b128 a[228:231], v2 offset:46080
    v_mfma_f32_16x16x32_bf16 v[168:171], a[208:211], a[136:139], v[168:171]
    v_mfma_f32_16x16x32_bf16 v[224:227], a[208:211], a[140:143], v[224:227]
    s_waitcnt lgkmcnt(2)
    ds_read_b128 a[232:235], v2 offset:47104
    v_mfma_f32_16x16x32_bf16 v[172:175], a[212:215], a[136:139], v[172:175]
    buffer_load_dwordx4 a[188:191], v2, s[32:35], s78 offen offset:3072 sc1
    v_mfma_f32_16x16x32_bf16 v[228:231], a[212:215], a[140:143], v[228:231]
    ds_read_b128 a[236:239], v2 offset:48128
    v_mfma_f32_16x16x32_bf16 v[176:179], a[216:219], a[136:139], v[176:179]
    s_add_u32 s78, s85, 1196032
    v_mfma_f32_16x16x32_bf16 v[232:235], a[216:219], a[140:143], v[232:235]
    s_barrier
    v_mfma_f32_16x16x32_bf16 v[180:183], a[220:223], a[136:139], v[180:183]
    buffer_load_dwordx4 a[192:195], v2, s[32:35], s78 offen offset:0 sc1
    v_mfma_f32_16x16x32_bf16 v[236:239], a[220:223], a[140:143], v[236:239]
    s_waitcnt lgkmcnt(1)
    ds_read_b128 a[240:243], v2 offset:49152
    v_mfma_f32_16x16x32_bf16 v[160:163], a[224:227], a[144:147], v[160:163]
    ds_read_b128 a[244:247], v2 offset:50176
    v_mfma_f32_16x16x32_bf16 v[216:219], a[224:227], a[148:151], v[216:219]
    ds_read_b128 a[248:251], v2 offset:51200
    v_mfma_f32_16x16x32_bf16 v[164:167], a[228:231], a[144:147], v[164:167]
    v_mfma_f32_16x16x32_bf16 v[220:223], a[228:231], a[148:151], v[220:223]
    buffer_load_dwordx4 a[196:199], v2, s[32:35], s78 offen offset:1024 sc1
    v_mfma_f32_16x16x32_bf16 v[168:171], a[232:235], a[144:147], v[168:171]
    ds_read_b128 a[252:255], v2 offset:52224
    v_mfma_f32_16x16x32_bf16 v[224:227], a[232:235], a[148:151], v[224:227]
    s_waitcnt lgkmcnt(2)
    ds_read_b128 a[208:211], v2 offset:53248
    v_mfma_f32_16x16x32_bf16 v[172:175], a[236:239], a[144:147], v[172:175]
    v_mfma_f32_16x16x32_bf16 v[228:231], a[236:239], a[148:151], v[228:231]
    buffer_load_dwordx4 a[200:203], v2, s[32:35], s78 offen offset:2048 sc1
    v_mfma_f32_16x16x32_bf16 v[176:179], a[240:243], a[144:147], v[176:179]
    ds_read_b128 a[212:215], v2 offset:54272
    v_mfma_f32_16x16x32_bf16 v[232:235], a[240:243], a[148:151], v[232:235]
    ds_read_b128 a[216:219], v2 offset:55296
    v_mfma_f32_16x16x32_bf16 v[180:183], a[244:247], a[144:147], v[180:183]
    v_mfma_f32_16x16x32_bf16 v[236:239], a[244:247], a[148:151], v[236:239]
    s_waitcnt lgkmcnt(2)
    buffer_load_dwordx4 a[204:207], v2, s[32:35], s78 offen offset:3072 sc1
    v_mfma_f32_16x16x32_bf16 v[160:163], a[248:251], a[152:155], v[160:163]
    ds_read_b128 a[220:223], v2 offset:56320
    v_mfma_f32_16x16x32_bf16 v[216:219], a[248:251], a[156:159], v[216:219]
    s_add_u32 s78, s85, 1200128
    ds_read_b128 a[224:227], v2 offset:57344
    v_mfma_f32_16x16x32_bf16 v[164:167], a[252:255], a[152:155], v[164:167]
    ds_read_b128 a[228:231], v2 offset:58368
    v_mfma_f32_16x16x32_bf16 v[220:223], a[252:255], a[156:159], v[220:223]
    buffer_load_dwordx4 a[0:3], v2, s[32:35], s78 offen offset:0 sc1
    v_mfma_f32_16x16x32_bf16 v[168:171], a[208:211], a[152:155], v[168:171]
    ds_read_b128 a[232:235], v2 offset:59392
    v_mfma_f32_16x16x32_bf16 v[224:227], a[208:211], a[156:159], v[224:227]
    s_waitcnt lgkmcnt(3)
    ds_read_b128 a[236:239], v2 offset:60416
    v_mfma_f32_16x16x32_bf16 v[172:175], a[212:215], a[152:155], v[172:175]
    ds_read_b128 a[240:243], v2 offset:61440
    v_mfma_f32_16x16x32_bf16 v[228:231], a[212:215], a[156:159], v[228:231]
    ds_read_b128 a[244:247], v2 offset:62464
    v_mfma_f32_16x16x32_bf16 v[176:179], a[216:219], a[152:155], v[176:179]
    buffer_load_dwordx4 a[4:7], v2, s[32:35], s78 offen offset:1024 sc1
    v_mfma_f32_16x16x32_bf16 v[232:235], a[216:219], a[156:159], v[232:235]
    ds_read_b128 a[248:251], v2 offset:63488
    v_mfma_f32_16x16x32_bf16 v[180:183], a[220:223], a[152:155], v[180:183]
    ds_read_b128 a[252:255], v2 offset:64512
    v_mfma_f32_16x16x32_bf16 v[236:239], a[220:223], a[156:159], v[236:239]
    s_waitcnt vmcnt(13) lgkmcnt(3)
    s_barrier
    ds_read_b128 a[208:211], v3 offset:0
    v_mfma_f32_16x16x32_bf16 v[128:131], a[224:227], a[160:163], 0
    buffer_load_dwordx4 a[8:11], v2, s[32:35], s78 offen offset:2048 sc1
    ds_read_b128 a[212:215], v3 offset:1024
    v_mul_f32 v160, v160, v164
    v_mul_f32 v161, v161, v165
    v_mfma_f32_16x16x32_bf16 v[132:135], a[228:231], a[160:163], 0
    ds_read_b128 a[216:219], v3 offset:2048
    v_mul_f32 v162, v162, v166
    v_mul_f32 v163, v163, v167
    v_cvt_pk_bf16_f32 v40, v160, v161
    v_mfma_f32_16x16x32_bf16 v[136:139], a[232:235], a[160:163], 0
    buffer_load_dwordx4 a[12:15], v2, s[32:35], s78 offen offset:3072 sc1
    ds_read_b128 a[220:223], v3 offset:3072
    v_cvt_pk_bf16_f32 v41, v162, v163
    v_mul_f32 v216, v216, v220
    v_mfma_f32_16x16x32_bf16 v[140:143], a[236:239], a[160:163], 0
    s_add_u32 s78, s85, 1212416
    ds_read_b128 a[224:227], v3 offset:4096
    v_mul_f32 v217, v217, v221
    v_mul_f32 v218, v218, v222
    v_mfma_f32_16x16x32_bf16 v[144:147], a[240:243], a[160:163], 0
    s_waitcnt vmcnt(14) lgkmcnt(4)
    ds_read_b128 a[228:231], v3 offset:5120
    v_mul_f32 v219, v219, v223
    v_cvt_pk_bf16_f32 v44, v216, v217
    v_mfma_f32_16x16x32_bf16 v[128:131], a[244:247], a[164:167], v[128:131]
    buffer_load_dwordx4 a[16:19], v2, s[32:35], s78 offen offset:0 sc1
    ds_read_b128 a[232:235], v3 offset:6144
    v_cvt_pk_bf16_f32 v45, v218, v219
    v_mul_f32 v168, v168, v172
    v_mfma_f32_16x16x32_bf16 v[132:135], a[248:251], a[164:167], v[132:135]
    ds_read_b128 a[236:239], v3 offset:7168
    v_mul_f32 v169, v169, v173
    v_mul_f32 v170, v170, v174
    v_mul_f32 v171, v171, v175
    v_mfma_f32_16x16x32_bf16 v[136:139], a[252:255], a[164:167], v[136:139]
    ds_read_b128 a[240:243], v3 offset:8192
    v_cvt_pk_bf16_f32 v42, v168, v169
    v_cvt_pk_bf16_f32 v43, v170, v171
    v_mul_f32 v224, v224, v228
    v_mfma_f32_16x16x32_bf16 v[140:143], a[208:211], a[164:167], v[140:143]
    s_waitcnt lgkmcnt(4)
    buffer_load_dwordx4 a[20:23], v2, s[32:35], s78 offen offset:1024 sc1
    ds_read_b128 a[244:247], v3 offset:9216
    v_mul_f32 v225, v225, v229
    v_mfma_f32_16x16x32_bf16 v[144:147], a[212:215], a[164:167], v[144:147]
    s_waitcnt vmcnt(15) lgkmcnt(4)
    ds_read_b128 a[248:251], v3 offset:10240
    v_mul_f32 v226, v226, v230
    v_mul_f32 v227, v227, v231
    v_mfma_f32_16x16x32_bf16 v[128:131], a[216:219], a[168:171], v[128:131]
    ds_read_b128 a[252:255], v3 offset:11264
    v_cvt_pk_bf16_f32 v46, v224, v225
    v_cvt_pk_bf16_f32 v47, v226, v227
    v_mul_f32 v176, v176, v180
    v_mfma_f32_16x16x32_bf16 v[132:135], a[220:223], a[168:171], v[132:135]
    buffer_load_dwordx4 a[24:27], v2, s[32:35], s78 offen offset:2048 sc1
    ds_read_b128 a[208:211], v3 offset:12288
    v_mul_f32 v177, v177, v181
    v_mul_f32 v178, v178, v182
    v_mfma_f32_16x16x32_bf16 v[136:139], a[224:227], a[168:171], v[136:139]
    s_add_u32 m0, s65, 8192
    s_add_u32 s47, s71, 106496
    ds_read_b128 a[212:215], v3 offset:13312
    v_mul_f32 v179, v179, v183
    v_mfma_f32_16x16x32_bf16 v[140:143], a[228:231], a[168:171], v[140:143]
    s_waitcnt lgkmcnt(4)
    ds_read_b128 a[216:219], v3 offset:14336
    v_cvt_pk_bf16_f32 v48, v176, v177
    v_cvt_pk_bf16_f32 v49, v178, v179
    v_mfma_f32_16x16x32_bf16 v[144:147], a[232:235], a[168:171], v[144:147]
    s_waitcnt vmcnt(15) lgkmcnt(4)
    buffer_load_dwordx4 v2, s[32:35], s47 offen sc1 lds
    ds_read_b128 a[220:223], v3 offset:15360
    v_mul_f32 v232, v232, v236
    v_mfma_f32_16x16x32_bf16 v[128:131], a[236:239], a[172:175], v[128:131]
    s_barrier
    ds_read_b128 a[224:227], v4 offset:8192
    v_mul_f32 v233, v233, v237
    v_mul_f32 v234, v234, v238
    v_mfma_f32_16x16x32_bf16 v[132:135], a[240:243], a[172:175], v[132:135]
    ds_read_b128 a[228:231], v4 offset:9216
    v_mul_f32 v235, v235, v239
    v_cvt_pk_bf16_f32 v50, v232, v233
    v_cvt_pk_bf16_f32 v51, v234, v235
    v_mfma_f32_16x16x32_bf16 v[136:139], a[244:247], a[172:175], v[136:139]
    buffer_load_dwordx4 v2, s[32:35], s47 offen offset:1024 sc1 lds
    ds_read_b128 a[232:235], v4 offset:10240
    v_mfma_f32_16x16x32_bf16 v[140:143], a[248:251], a[172:175], v[140:143]
    s_waitcnt lgkmcnt(4)
    s_add_u32 m0, s65, 16384
    ds_read_b128 a[236:239], v4 offset:11264
    v_permlane32_swap_b32 v48, v50
    v_mfma_f32_16x16x32_bf16 v[144:147], a[252:255], a[172:175], v[144:147]
    s_waitcnt vmcnt(16) lgkmcnt(4)
    s_add_u32 s47, s71, 114688
    ds_read_b128 a[240:243], v4 offset:12288
    v_permlane32_swap_b32 v49, v51
    v_mfma_f32_16x16x32_bf16 v[128:131], a[208:211], a[176:179], v[128:131]
    buffer_store_dwordx4 v[40:43], v2, s[32:35], s79 offen sc1
    ds_read_b128 a[244:247], v4 offset:13312
    v_mfma_f32_16x16x32_bf16 v[132:135], a[212:215], a[176:179], v[132:135]
    buffer_store_dwordx4 v[44:47], v2, s[32:35], s80 offen sc1
    ds_read_b128 a[248:251], v4 offset:14336
    v_mfma_f32_16x16x32_bf16 v[136:139], a[216:219], a[176:179], v[136:139]
    buffer_store_dwordx4 v[48:51], v25, s[32:35], s81 offen sc1
    ds_read_b128 a[252:255], v4 offset:15360
    v_mfma_f32_16x16x32_bf16 v[140:143], a[220:223], a[176:179], v[140:143]
    s_waitcnt lgkmcnt(4)
    buffer_load_dwordx4 v2, s[32:35], s47 offen sc1 lds
    ds_read_b128 a[208:211], v4 offset:16384
    v_mfma_f32_16x16x32_bf16 v[144:147], a[224:227], a[176:179], v[144:147]
    s_waitcnt vmcnt(19) lgkmcnt(4)
    ds_read_b128 a[212:215], v4 offset:17408
    v_mfma_f32_16x16x32_bf16 v[128:131], a[228:231], a[180:183], v[128:131]
    buffer_load_dwordx4 v2, s[32:35], s47 offen offset:1024 sc1 lds
    ds_read_b128 a[216:219], v4 offset:18432
    v_mfma_f32_16x16x32_bf16 v[132:135], a[232:235], a[180:183], v[132:135]
    ds_read_b128 a[220:223], v4 offset:19456
    v_mfma_f32_16x16x32_bf16 v[136:139], a[236:239], a[180:183], v[136:139]
    ds_read_b128 a[224:227], v4 offset:20480
    v_mfma_f32_16x16x32_bf16 v[140:143], a[240:243], a[180:183], v[140:143]
    s_waitcnt lgkmcnt(4)
    buffer_load_dwordx4 a[28:31], v2, s[32:35], s78 offen offset:3072 sc1
    ds_read_b128 a[228:231], v4 offset:21504
    v_mfma_f32_16x16x32_bf16 v[144:147], a[244:247], a[180:183], v[144:147]
    s_waitcnt vmcnt(20) lgkmcnt(4)
    s_add_u32 s78, s85, 1216512
    ds_read_b128 a[232:235], v4 offset:22528
    v_mfma_f32_16x16x32_bf16 v[128:131], a[248:251], a[184:187], v[128:131]
    ds_read_b128 a[236:239], v4 offset:23552
    v_mfma_f32_16x16x32_bf16 v[132:135], a[252:255], a[184:187], v[132:135]
    s_barrier
    buffer_load_dwordx4 a[32:35], v2, s[32:35], s78 offen offset:0 sc1
    ds_read_b128 a[240:243], v3 offset:16384
    v_mfma_f32_16x16x32_bf16 v[136:139], a[208:211], a[184:187], v[136:139]
    ds_read_b128 a[244:247], v3 offset:17408
    v_mfma_f32_16x16x32_bf16 v[140:143], a[212:215], a[184:187], v[140:143]
    s_waitcnt lgkmcnt(4)
    ds_read_b128 a[248:251], v3 offset:18432
    v_mfma_f32_16x16x32_bf16 v[144:147], a[216:219], a[184:187], v[144:147]
    s_waitcnt vmcnt(20) lgkmcnt(4)
    buffer_load_dwordx4 a[36:39], v2, s[32:35], s78 offen offset:1024 sc1
    ds_read_b128 a[252:255], v3 offset:19456
    v_mfma_f32_16x16x32_bf16 v[128:131], a[220:223], a[188:191], v[128:131]
    s_add_u32 m0, s65, 24576
    s_add_u32 s47, s71, 122880
    ds_read_b128 a[208:211], v3 offset:20480
    v_mfma_f32_16x16x32_bf16 v[132:135], a[224:227], a[188:191], v[132:135]
    ds_read_b128 a[212:215], v3 offset:21504
    v_mfma_f32_16x16x32_bf16 v[136:139], a[228:231], a[188:191], v[136:139]
    buffer_load_dwordx4 v2, s[32:35], s47 offen sc1 lds
    ds_read_b128 a[216:219], v3 offset:22528
    v_mfma_f32_16x16x32_bf16 v[140:143], a[232:235], a[188:191], v[140:143]
    s_waitcnt lgkmcnt(4)
    ds_read_b128 a[220:223], v3 offset:23552
    v_mfma_f32_16x16x32_bf16 v[144:147], a[236:239], a[188:191], v[144:147]
    s_waitcnt vmcnt(21) lgkmcnt(4)
    ds_read_b128 a[224:227], v3 offset:24576
    v_mfma_f32_16x16x32_bf16 v[128:131], a[240:243], a[192:195], v[128:131]
    buffer_load_dwordx4 v2, s[32:35], s47 offen offset:1024 sc1 lds
    ds_read_b128 a[228:231], v3 offset:25600
    v_mfma_f32_16x16x32_bf16 v[132:135], a[244:247], a[192:195], v[132:135]
    s_add_u32 m0, s65, 32768
    s_add_u32 s47, s71, 131072
    ds_read_b128 a[232:235], v3 offset:26624
    v_mfma_f32_16x16x32_bf16 v[136:139], a[248:251], a[192:195], v[136:139]
    ds_read_b128 a[236:239], v3 offset:27648
    v_mfma_f32_16x16x32_bf16 v[140:143], a[252:255], a[192:195], v[140:143]
    s_waitcnt lgkmcnt(4)
    buffer_load_dwordx4 v2, s[32:35], s47 offen sc1 lds
    ds_read_b128 a[240:243], v3 offset:28672
    v_mfma_f32_16x16x32_bf16 v[144:147], a[208:211], a[192:195], v[144:147]
    s_waitcnt vmcnt(22) lgkmcnt(4)
    ds_read_b128 a[244:247], v3 offset:29696
    v_mfma_f32_16x16x32_bf16 v[128:131], a[212:215], a[196:199], v[128:131]
    ds_read_b128 a[248:251], v3 offset:30720
    v_mfma_f32_16x16x32_bf16 v[132:135], a[216:219], a[196:199], v[132:135]
    buffer_load_dwordx4 v2, s[32:35], s47 offen offset:1024 sc1 lds
    ds_read_b128 a[252:255], v3 offset:31744
    v_mfma_f32_16x16x32_bf16 v[136:139], a[220:223], a[196:199], v[136:139]
    s_barrier
    s_waitcnt vmcnt(9)
    ds_read_b128 a[208:211], v3 offset:32768
    v_add_u32 v22, 1, v22
    v_mfma_f32_16x16x32_bf16 v[140:143], a[224:227], a[196:199], v[140:143]
    s_waitcnt lgkmcnt(4)
    s_add_u32 s67, s46, 65536
    ds_read_b128 a[212:215], v3 offset:33792
    v_mfma_f32_16x16x32_bf16 v[144:147], a[228:231], a[196:199], v[144:147]
    buffer_store_dword v22, v60, s[32:35], s67 offen sc1
    ds_read_b128 a[216:219], v3 offset:34816
    v_mfma_f32_16x16x32_bf16 v[128:131], a[232:235], a[200:203], v[128:131]
    buffer_load_dwordx4 a[40:43], v2, s[32:35], s78 offen offset:2048 sc1
    ds_read_b128 a[220:223], v3 offset:35840
    v_mfma_f32_16x16x32_bf16 v[132:135], a[236:239], a[200:203], v[132:135]
    ds_read_b128 a[224:227], v3 offset:36864
    v_mfma_f32_16x16x32_bf16 v[136:139], a[240:243], a[200:203], v[136:139]
    s_waitcnt lgkmcnt(4)
    buffer_load_dwordx4 a[44:47], v2, s[32:35], s78 offen offset:3072 sc1
    ds_read_b128 a[228:231], v3 offset:37888
    v_mfma_f32_16x16x32_bf16 v[140:143], a[244:247], a[200:203], v[140:143]
    s_add_u32 s78, s85, 1228800
    ds_read_b128 a[232:235], v3 offset:38912
    v_mfma_f32_16x16x32_bf16 v[144:147], a[248:251], a[200:203], v[144:147]
    ds_read_b128 a[236:239], v3 offset:39936
    v_mfma_f32_16x16x32_bf16 v[128:131], a[252:255], a[204:207], v[128:131]
    buffer_load_dwordx4 a[48:51], v2, s[32:35], s78 offen offset:0 sc1
    ds_read_b128 a[240:243], v3 offset:40960
    v_mfma_f32_16x16x32_bf16 v[132:135], a[208:211], a[204:207], v[132:135]
    s_waitcnt lgkmcnt(4)
    ds_read_b128 a[244:247], v3 offset:41984
    v_mfma_f32_16x16x32_bf16 v[136:139], a[212:215], a[204:207], v[136:139]
    ds_read_b128 a[248:251], v3 offset:43008
    v_mfma_f32_16x16x32_bf16 v[140:143], a[216:219], a[204:207], v[140:143]
    buffer_load_dwordx4 a[52:55], v2, s[32:35], s78 offen offset:1024 sc1
    ds_read_b128 a[252:255], v3 offset:44032
    v_mfma_f32_16x16x32_bf16 v[144:147], a[220:223], a[204:207], v[144:147]
    s_add_u32 m0, s65, 40960
    s_add_u32 s47, s71, 139264
    ds_read_b128 a[208:211], v3 offset:45056
    v_mfma_f32_16x16x32_bf16 v[128:131], a[224:227], a[0:3], v[128:131]
    s_waitcnt lgkmcnt(4)
    ds_read_b128 a[212:215], v3 offset:46080
    v_mfma_f32_16x16x32_bf16 v[132:135], a[228:231], a[0:3], v[132:135]
    buffer_load_dwordx4 v2, s[32:35], s47 offen sc1 lds
    ds_read_b128 a[216:219], v3 offset:47104
    v_mfma_f32_16x16x32_bf16 v[136:139], a[232:235], a[0:3], v[136:139]
    ds_read_b128 a[220:223], v3 offset:48128
    v_mfma_f32_16x16x32_bf16 v[140:143], a[236:239], a[0:3], v[140:143]
    s_barrier
    ds_read_b128 a[224:227], v3 offset:49152
    v_mfma_f32_16x16x32_bf16 v[144:147], a[240:243], a[0:3], v[144:147]
    s_waitcnt lgkmcnt(4)
    buffer_load_dwordx4 v2, s[32:35], s47 offen offset:1024 sc1 lds
    ds_read_b128 a[228:231], v3 offset:50176
    v_mfma_f32_16x16x32_bf16 v[128:131], a[244:247], a[4:7], v[128:131]
    s_add_u32 m0, s65, 49152
    s_add_u32 s47, s71, 147456
    ds_read_b128 a[232:235], v3 offset:51200
    v_mfma_f32_16x16x32_bf16 v[132:135], a[248:251], a[4:7], v[132:135]
    ds_read_b128 a[236:239], v3 offset:52224
    v_mfma_f32_16x16x32_bf16 v[136:139], a[252:255], a[4:7], v[136:139]
    buffer_load_dwordx4 v2, s[32:35], s47 offen sc1 lds
    ds_read_b128 a[240:243], v3 offset:53248
    v_mfma_f32_16x16x32_bf16 v[140:143], a[208:211], a[4:7], v[140:143]
    s_waitcnt lgkmcnt(4)
    ds_read_b128 a[244:247], v3 offset:54272
    v_mfma_f32_16x16x32_bf16 v[144:147], a[212:215], a[4:7], v[144:147]
    ds_read_b128 a[248:251], v3 offset:55296
    v_mfma_f32_16x16x32_bf16 v[128:131], a[216:219], a[8:11], v[128:131]
    buffer_load_dwordx4 v2, s[32:35], s47 offen offset:1024 sc1 lds
    ds_read_b128 a[252:255], v3 offset:56320
    v_mfma_f32_16x16x32_bf16 v[132:135], a[220:223], a[8:11], v[132:135]
    ds_read_b128 a[208:211], v3 offset:57344
    v_mfma_f32_16x16x32_bf16 v[136:139], a[224:227], a[8:11], v[136:139]
    s_waitcnt lgkmcnt(4)
    ds_read_b128 a[212:215], v3 offset:58368
    v_mfma_f32_16x16x32_bf16 v[140:143], a[228:231], a[8:11], v[140:143]
    buffer_load_dwordx4 a[56:59], v2, s[32:35], s78 offen offset:2048 sc1
    ds_read_b128 a[216:219], v3 offset:59392
    v_mfma_f32_16x16x32_bf16 v[144:147], a[232:235], a[8:11], v[144:147]
    s_add_u32 s3, s46, 65536
    ds_read_b128 a[220:223], v3 offset:60416
    v_mfma_f32_16x16x32_bf16 v[128:131], a[236:239], a[12:15], v[128:131]
    buffer_load_dword v24, v243, s[32:35], s3 offen sc1
    ds_read_b128 a[224:227], v3 offset:61440
    v_mov_b32 v27, 161408
    v_lshl_add_u32 v25, v5, 5, v27
    v_mfma_f32_16x16x32_bf16 v[132:135], a[240:243], a[12:15], v[132:135]
    s_waitcnt lgkmcnt(4)
    buffer_load_dwordx4 a[60:63], v2, s[32:35], s78 offen offset:3072 sc1
    ds_read_b128 a[228:231], v3 offset:62464
    v_and_b32 v26, 1, v5
    v_mfma_f32_16x16x32_bf16 v[136:139], a[244:247], a[12:15], v[136:139]
    s_add_u32 s78, s85, 1232896
    ds_read_b128 a[232:235], v3 offset:63488
    v_lshl_add_u32 v26, v26, 5, v27
    v_lshrrev_b32 v27, 1, v5
    v_mfma_f32_16x16x32_bf16 v[140:143], a[248:251], a[12:15], v[140:143]
    ds_read_b128 a[236:239], v3 offset:64512
    v_lshl_add_u32 v26, v27, 4, v26
    v_mfma_f32_16x16x32_bf16 v[144:147], a[252:255], a[12:15], v[144:147]
    s_barrier
    buffer_load_dwordx4 a[64:67], v2, s[32:35], s78 offen offset:0 sc1
    ds_read_b128 a[240:243], v4 offset:0
    v_mfma_f32_16x16x32_bf16 v[128:131], a[208:211], a[16:19], v[128:131]
    s_waitcnt lgkmcnt(4)
    s_add_u32 m0, s65, 57344
    ds_read_b128 a[244:247], v4 offset:1024
    ds_read_b128 v[64:67], v25 offset:0
    v_mfma_f32_16x16x32_bf16 v[132:135], a[212:215], a[16:19], v[132:135]
    s_add_u32 s47, s71, 155648
    ds_read_b128 a[248:251], v4 offset:2048
    ds_read_b128 v[68:71], v25 offset:16
    ds_read_b128 v[72:75], v25 offset:128
    v_mfma_f32_16x16x32_bf16 v[136:139], a[216:219], a[16:19], v[136:139]
    buffer_load_dwordx4 v2, s[32:35], s47 offen sc1 lds
    ds_read_b128 a[252:255], v4 offset:3072
    v_mfma_f32_16x16x32_bf16 v[140:143], a[220:223], a[16:19], v[140:143]
    ds_read_b128 a[208:211], v4 offset:4096
    ds_read_b128 v[76:79], v25 offset:144
L_pad7:
    s_cbranch_execz L_hopped
    ds_read_b128 v[80:83], v26 offset:256
    v_mfma_f32_16x16x32_bf16 v[144:147], a[224:227], a[16:19], v[144:147]
    s_waitcnt lgkmcnt(9)
    s_and_b32 s77, s73, 7
    ds_read_b128 a[212:215], v4 offset:5120
    v_mfma_f32_16x16x32_bf16 v[128:131], a[228:231], a[20:23], v[128:131]
    s_lshl_b32 s77, s77, 6
    s_add_u32 s77, s77, 159744
    buffer_load_dwordx4 v2, s[32:35], s47 offen offset:1024 sc1 lds
    ds_read_b128 a[216:219], v4 offset:6144
    v_mfma_f32_16x16x32_bf16 v[132:135], a[232:235], a[20:23], v[132:135]
    s_add_u32 m0, s65, 65536
    s_add_u32 s47, s71, 163840
    ds_read_b128 a[220:223], v4 offset:7168
    v_lshl_add_u32 v29, v6, 2, s77
    v_mfma_f32_16x16x32_bf16 v[136:139], a[236:239], a[20:23], v[136:139]
    ds_read_b128 a[224:227], v2 offset:0
    ds_read_b32 v29, v29
    v_lshlrev_b32 v104, 16, v12
    v_and_b32 v105, 0xffff0000, v12
    v_mfma_f32_16x16x32_bf16 v[140:143], a[240:243], a[20:23], v[140:143]
    s_waitcnt lgkmcnt(7)
    buffer_load_dwordx4 v2, s[32:35], s47 offen sc1 lds
    ds_read_b128 a[228:231], v2 offset:1024
    v_lshlrev_b32 v106, 16, v13
    v_mfma_f32_16x16x32_bf16 v[144:147], a[244:247], a[20:23], v[144:147]
    ds_read_b128 a[232:235], v2 offset:2048
    v_and_b32 v107, 0xffff0000, v13
    v_lshlrev_b32 v108, 16, v14
    v_and_b32 v109, 0xffff0000, v14
    v_mfma_f32_16x16x32_bf16 v[128:131], a[248:251], a[24:27], v[128:131]
    ds_read_b128 a[236:239], v2 offset:3072
    v_lshlrev_b32 v110, 16, v15
    v_and_b32 v111, 0xffff0000, v15
    v_lshlrev_b32 v112, 16, v16
    v_mfma_f32_16x16x32_bf16 v[132:135], a[252:255], a[24:27], v[132:135]
    buffer_load_dwordx4 v2, s[32:35], s47 offen offset:1024 sc1 lds
    ds_read_b128 a[240:243], v2 offset:4096
    v_and_b32 v113, 0xffff0000, v16
    v_lshlrev_b32 v114, 16, v17
    v_mfma_f32_16x16x32_bf16 v[136:139], a[208:211], a[24:27], v[136:139]
    s_waitcnt lgkmcnt(5)
    ds_read_b128 a[244:247], v2 offset:5120
    v_and_b32 v115, 0xffff0000, v17
    v_lshlrev_b32 v116, 16, v18
    v_mfma_f32_16x16x32_bf16 v[140:143], a[212:215], a[24:27], v[140:143]
    ds_read_b128 a[248:251], v2 offset:6144
    v_and_b32 v117, 0xffff0000, v18
    v_lshlrev_b32 v118, 16, v19
    v_and_b32 v119, 0xffff0000, v19
    v_mfma_f32_16x16x32_bf16 v[144:147], a[216:219], a[24:27], v[144:147]
    s_waitcnt vmcnt(23) lgkmcnt(4)
    buffer_load_dwordx4 a[68:71], v2, s[32:35], s78 offen offset:1024 sc1
    ds_read_b128 a[252:255], v2 offset:7168
    v_lshlrev_b32 v120, 16, v20
    v_mfma_f32_16x16x32_bf16 v[128:131], a[220:223], a[28:31], v[128:131]
    s_barrier
    ds_read_b128 a[208:211], v2 offset:8192
    v_and_b32 v121, 0xffff0000, v20
    v_lshlrev_b32 v122, 16, v21
    v_mfma_f32_16x16x32_bf16 v[132:135], a[224:227], a[28:31], v[132:135]
    ds_read_b128 a[212:215], v2 offset:9216
    v_and_b32 v123, 0xffff0000, v21
    v_mul_u32_u24 v28, 1280, v6
    v_lshl_add_u32 v28, v5, 4, v28
    v_mfma_f32_16x16x32_bf16 v[136:139], a[228:231], a[28:31], v[136:139]
    s_mul_i32 s80, s73, 20480
    s_mul_i32 s77, s74, 160
    buffer_load_dwordx4 a[72:75], v2, s[32:35], s78 offen offset:2048 sc1
    ds_read_b128 a[216:219], v2 offset:10240
    v_mfma_f32_16x16x32_bf16 v[140:143], a[232:235], a[28:31], v[140:143]
    s_waitcnt lgkmcnt(4)
    s_add_u32 s80, s80, s77
    ds_read_b128 a[220:223], v2 offset:11264
    v_mfma_f32_16x16x32_bf16 v[144:147], a[236:239], a[28:31], v[144:147]
    s_waitcnt vmcnt(24) lgkmcnt(4)
    ds_read_b128 a[224:227], v2 offset:12288
    v_mul_f32 v64, v64, v29
    v_mul_f32 v65, v65, v29
    v_mfma_f32_16x16x32_bf16 v[128:131], a[240:243], a[32:35], v[128:131]
    buffer_load_dwordx4 a[76:79], v2, s[32:35], s78 offen offset:3072 sc1
    ds_read_b128 a[228:231], v2 offset:13312
    v_mul_f32 v66, v66, v29
    v_mul_f32 v67, v67, v29
    v_mfma_f32_16x16x32_bf16 v[132:135], a[244:247], a[32:35], v[132:135]
    s_add_u32 m0, s65, 73728
    s_add_u32 s47, s71, 172032
    ds_read_b128 a[232:235], v2 offset:14336
    v_mul_f32 v68, v68, v29
    v_mfma_f32_16x16x32_bf16 v[136:139], a[248:251], a[32:35], v[136:139]
    ds_read_b128 a[236:239], v2 offset:15360
    v_mul_f32 v69, v69, v29
    v_mul_f32 v70, v70, v29
    v_mul_f32 v71, v71, v29
    v_mfma_f32_16x16x32_bf16 v[140:143], a[252:255], a[32:35], v[140:143]
    s_waitcnt lgkmcnt(4)
    buffer_load_dwordx4 v2, s[32:35], s47 offen sc1 lds
    ds_read_b128 a[240:243], v2 offset:16384
    v_mul_f32 v72, v72, v29
    v_mfma_f32_16x16x32_bf16 v[144:147], a[208:211], a[32:35], v[144:147]
    s_waitcnt vmcnt(25) lgkmcnt(4)
    ds_read_b128 a[244:247], v2 offset:17408
    v_mul_f32 v73, v73, v29
    v_mul_f32 v74, v74, v29
    v_mfma_f32_16x16x32_bf16 v[128:131], a[212:215], a[36:39], v[128:131]
    ds_read_b128 a[248:251], v2 offset:18432
    v_mul_f32 v75, v75, v29
    v_mul_f32 v76, v76, v29
    v_mul_f32 v77, v77, v29
    v_mfma_f32_16x16x32_bf16 v[132:135], a[216:219], a[36:39], v[132:135]
    buffer_load_dwordx4 v2, s[32:35], s47 offen offset:1024 sc1 lds
    ds_read_b128 a[252:255], v2 offset:19456
    v_mul_f32 v78, v78, v29
    v_mul_f32 v79, v79, v29
    v_mfma_f32_16x16x32_bf16 v[136:139], a[220:223], a[36:39], v[136:139]
    s_add_u32 m0, s65, 139264
    s_add_u32 s47, s71, 180224
    ds_read_b128 a[208:211], v2 offset:20480
    v_mul_f32 v80, v80, v29
    v_mfma_f32_16x16x32_bf16 v[140:143], a[224:227], a[36:39], v[140:143]
    s_waitcnt lgkmcnt(4)
    ds_read_b128 a[212:215], v2 offset:21504
    v_mul_f32 v81, v81, v29
    v_mul_f32 v82, v82, v29
    v_mfma_f32_16x16x32_bf16 v[144:147], a[228:231], a[36:39], v[144:147]
    s_waitcnt vmcnt(20) lgkmcnt(4)
    buffer_load_dwordx4 v2, s[32:35], s47 offen sc1 lds
    ds_read_b128 a[216:219], v2 offset:22528
    v_mul_f32 v83, v83, v29
    v_mfma_f32_16x16x32_bf16 v[128:131], a[232:235], a[40:43], v[128:131]
    ds_read_b128 a[220:223], v2 offset:23552
    v_mfma_f32_16x16x32_bf16 v[132:135], a[236:239], a[40:43], v[132:135]
    s_barrier
    ds_read_b128 a[224:227], v2 offset:24576
    v_mfma_f32_16x16x32_bf16 v[136:139], a[240:243], a[40:43], v[136:139]
    buffer_load_dwordx4 v2, s[32:35], s47 offen offset:1024 sc1 lds
    ds_read_b128 a[228:231], v2 offset:25600
    v_mfma_f32_16x16x32_bf16 v[140:143], a[244:247], a[40:43], v[140:143]
    s_waitcnt lgkmcnt(4)
    ds_read_b128 a[232:235], v2 offset:26624
    v_mfma_f32_16x16x32_bf16 v[144:147], a[248:251], a[40:43], v[144:147]
    s_waitcnt vmcnt(21) lgkmcnt(4)
    ds_read_b128 a[236:239], v2 offset:27648
    v_mfma_f32_16x16x32_bf16 v[128:131], a[252:255], a[44:47], v[128:131]
    s_waitcnt vmcnt(13)
    v_subrev_u32 v24, s64, v24
    v_subrev_u32 v24, 4, v24
    v_cmp_lt_u32 vcc, 7, v24
    s_nop 0
    s_cbranch_vccz L_probed_37
    s_mov_b32 s67, 0
L_poll_38:
    s_add_u32 s76, s46, 65536
    buffer_load_dword v24, v243, s[32:35], s76 offen sc1
    s_waitcnt vmcnt(0)
    v_subrev_u32 v24, s64, v24
    v_subrev_u32 v24, 4, v24
    v_cmp_lt_u32 vcc, 7, v24
    s_nop 0
    s_cbranch_vccz L_ready_39
    s_add_u32 s67, s67, 1
    s_cmp_lt_u32 s67, 20000
    s_cbranch_scc1 L_poll_38
L_ready_39:
L_probed_37:
    ds_read_b128 a[240:243], v2 offset:28672
    v_mfma_f32_16x16x32_bf16 v[132:135], a[208:211], a[44:47], v[132:135]
    s_add_u32 s78, s85, 1245184
    ds_read_b128 a[244:247], v2 offset:29696
    v_mfma_f32_16x16x32_bf16 v[136:139], a[212:215], a[44:47], v[136:139]
    buffer_load_dwordx4 a[80:83], v2, s[32:35], s78 offen offset:0 sc1
    ds_read_b128 a[248:251], v2 offset:30720
    v_mfma_f32_16x16x32_bf16 v[140:143], a[216:219], a[44:47], v[140:143]
    s_waitcnt lgkmcnt(4)
    ds_read_b128 a[252:255], v2 offset:31744
    v_mfma_f32_16x16x32_bf16 v[144:147], a[220:223], a[44:47], v[144:147]
    buffer_load_dwordx4 a[84:87], v2, s[32:35], s78 offen offset:1024 sc1
    ds_read_b128 a[208:211], v2 offset:32768
    v_mfma_f32_16x16x32_bf16 v[128:131], a[224:227], a[48:51], v[128:131]
    ds_read_b128 a[212:215], v2 offset:33792
    v_mfma_f32_16x16x32_bf16 v[132:135], a[228:231], a[48:51], v[132:135]
    ds_read_b128 a[216:219], v2 offset:34816
    v_mfma_f32_16x16x32_bf16 v[136:139], a[232:235], a[48:51], v[136:139]
    s_waitcnt lgkmcnt(4)
    buffer_load_dwordx4 a[88:91], v2, s[32:35], s78 offen offset:2048 sc1
    ds_read_b128 a[220:223], v2 offset:35840
    v_mfma_f32_16x16x32_bf16 v[140:143], a[236:239], a[48:51], v[140:143]
    s_add_u32 m0, s65, 147456
    s_add_u32 s47, s71, 188416
    ds_read_b128 a[224:227], v2 offset:36864
    v_mfma_f32_16x16x32_bf16 v[144:147], a[240:243], a[48:51], v[144:147]
    ds_read_b128 a[228:231], v2 offset:37888
    v_mfma_f32_16x16x32_bf16 v[128:131], a[244:247], a[52:55], v[128:131]
    buffer_load_dwordx4 v2, s[32:35], s47 offen sc1 lds
    ds_read_b128 a[232:235], v2 offset:38912
    v_mfma_f32_16x16x32_bf16 v[132:135], a[248:251], a[52:55], v[132:135]
    s_waitcnt lgkmcnt(4)
    ds_read_b128 a[236:239], v2 offset:39936
    v_mfma_f32_16x16x32_bf16 v[136:139], a[252:255], a[52:55], v[136:139]
    s_barrier
    ds_read_b128 a[240:243], v2 offset:40960
    v_mfma_f32_16x16x32_bf16 v[140:143], a[208:211], a[52:55], v[140:143]
    buffer_load_dwordx4 v2, s[32:35], s47 offen offset:1024 sc1 lds
    ds_read_b128 a[244:247], v2 offset:41984
    v_mfma_f32_16x16x32_bf16 v[144:147], a[212:215], a[52:55], v[144:147]
    s_add_u32 m0, s65, 81920
    s_add_u32 s47, s71, 196608
    ds_read_b128 a[248:251], v2 offset:43008
    v_mfma_f32_16x16x32_bf16 v[128:131], a[216:219], a[56:59], v[128:131]
    s_waitcnt lgkmcnt(4)
    ds_read_b128 a[252:255], v2 offset:44032
    v_mfma_f32_16x16x32_bf16 v[132:135], a[220:223], a[56:59], v[132:135]
    buffer_load_dwordx4 v2, s[32:35], s47 offen sc1 lds
    ds_read_b128 a[208:211], v2 offset:45056
    v_mfma_f32_16x16x32_bf16 v[136:139], a[224:227], a[56:59], v[136:139]
    ds_read_b128 a[212:215], v2 offset:46080
    v_mfma_f32_16x16x32_bf16 v[140:143], a[228:231], a[56:59], v[140:143]
    ds_read_b128 a[216:219], v2 offset:47104
    v_mfma_f32_16x16x32_bf16 v[144:147], a[232:235], a[56:59], v[144:147]
    s_waitcnt vmcnt(18) lgkmcnt(4)
    buffer_load_dwordx4 v2, s[32:35], s47 offen offset:1024 sc1 lds
    ds_read_b128 a[220:223], v2 offset:48128
    v_mfma_f32_16x16x32_bf16 v[128:131], a[236:239], a[60:63], v[128:131]
    ds_read_b128 a[224:227], v2 offset:49152
    v_mfma_f32_16x16x32_bf16 v[132:135], a[240:243], a[60:63], v[132:135]
    ds_read_b128 a[228:231], v2 offset:50176
    v_mfma_f32_16x16x32_bf16 v[136:139], a[244:247], a[60:63], v[136:139]
    buffer_load_dwordx4 a[92:95], v2, s[32:35], s78 offen offset:3072 sc1
    ds_read_b128 a[232:235], v2 offset:51200
    v_mfma_f32_16x16x32_bf16 v[140:143], a[248:251], a[60:63], v[140:143]
    s_waitcnt lgkmcnt(4)
    s_add_u32 s78, s85, 1249280
    ds_read_b128 a[236:239], v2 offset:52224
    v_mfma_f32_16x16x32_bf16 v[144:147], a[252:255], a[60:63], v[144:147]
    s_waitcnt vmcnt(19) lgkmcnt(4)
    ds_read_b128 a[240:243], v2 offset:53248
    v_mfma_f32_16x16x32_bf16 v[128:131], a[208:211], a[64:67], v[128:131]
    buffer_load_dwordx4 a[96:99], v2, s[32:35], s78 offen offset:0 sc1
    ds_read_b128 a[244:247], v2 offset:54272
    v_mfma_f32_16x16x32_bf16 v[132:135], a[212:215], a[64:67], v[132:135]
    ds_read_b128 a[248:251], v2 offset:55296
    v_mfma_f32_16x16x32_bf16 v[136:139], a[216:219], a[64:67], v[136:139]
    ds_read_b128 a[252:255], v2 offset:56320
    v_mfma_f32_16x16x32_bf16 v[140:143], a[220:223], a[64:67], v[140:143]
    s_waitcnt lgkmcnt(4)
    s_waitcnt vmcnt(16)
    s_barrier
    buffer_load_dwordx4 a[100:103], v2, s[32:35], s78 offen offset:1024 sc1
    v_mfma_f32_16x16x32_bf16 v[144:147], a[224:227], a[64:67], v[144:147]
    s_waitcnt vmcnt(16) lgkmcnt(3)
    s_add_u32 m0, s65, 90112
    ds_read_b128 a[208:211], v2 offset:57344
    ds_read_b128 a[212:215], v2 offset:58368
    v_mfma_f32_16x16x32_bf16 v[128:131], a[228:231], a[68:71], v[128:131]
    s_add_u32 s47, s71, 204800
    ds_read_b128 a[216:219], v2 offset:59392
    v_mfma_f32_16x16x32_bf16 v[132:135], a[232:235], a[68:71], v[132:135]
    buffer_load_dwordx4 v2, s[32:35], s47 offen sc1 lds
    ds_read_b128 a[220:223], v2 offset:60416
    v_mfma_f32_16x16x32_bf16 v[136:139], a[236:239], a[68:71], v[136:139]
    ds_read_b128 a[224:227], v2 offset:61440
    v_mfma_f32_16x16x32_bf16 v[140:143], a[240:243], a[68:71], v[140:143]
    s_waitcnt lgkmcnt(5)
    ds_read_b128 a[228:231], v2 offset:62464
    v_mfma_f32_16x16x32_bf16 v[144:147], a[244:247], a[68:71], v[144:147]
    s_waitcnt vmcnt(16) lgkmcnt(4)
    buffer_load_dwordx4 v2, s[32:35], s47 offen offset:1024 sc1 lds
    ds_read_b128 a[232:235], v2 offset:63488
    v_mfma_f32_16x16x32_bf16 v[128:131], a[248:251], a[72:75], v[128:131]
    s_add_u32 m0, s65, 98304
    s_add_u32 s47, s71, 212992
    ds_read_b128 a[236:239], v2 offset:64512
    v_mfma_f32_16x16x32_bf16 v[132:135], a[252:255], a[72:75], v[132:135]
    ds_read_b128 a[240:243], v3 offset:0
    v_mfma_f32_16x16x32_bf16 v[136:139], a[208:211], a[72:75], v[136:139]
    buffer_load_dwordx4 v2, s[32:35], s47 offen sc1 lds
    ds_read_b128 a[244:247], v3 offset:1024
    v_mfma_f32_16x16x32_bf16 v[140:143], a[212:215], a[72:75], v[140:143]
    s_waitcnt lgkmcnt(4)
    ds_read_b128 a[248:251], v3 offset:2048
    v_mfma_f32_16x16x32_bf16 v[144:147], a[216:219], a[72:75], v[144:147]
    s_waitcnt vmcnt(17) lgkmcnt(4)
    ds_read_b128 a[252:255], v3 offset:3072
    v_mfma_f32_16x16x32_bf16 v[128:131], a[220:223], a[76:79], v[128:131]
    buffer_load_dwordx4 v2, s[32:35], s47 offen offset:1024 sc1 lds
    ds_read_b128 a[208:211], v3 offset:4096
    v_mfma_f32_16x16x32_bf16 v[132:135], a[224:227], a[76:79], v[132:135]
    ds_read_b128 a[212:215], v3 offset:5120
    v_mfma_f32_16x16x32_bf16 v[136:139], a[228:231], a[76:79], v[136:139]
    ds_read_b128 a[216:219], v3 offset:6144
    v_mfma_f32_16x16x32_bf16 v[140:143], a[232:235], a[76:79], v[140:143]
    s_waitcnt lgkmcnt(4)
    buffer_load_dwordx4 a[104:107], v2, s[32:35], s78 offen offset:2048 sc1
    ds_read_b128 a[220:223], v3 offset:7168
    v_mfma_f32_16x16x32_bf16 v[144:147], a[236:239], a[76:79], v[144:147]
    s_waitcnt vmcnt(14) lgkmcnt(4)
    s_barrier
    ds_read_b128 a[224:227], v3 offset:8192
    v_mfma_f32_16x16x32_bf16 v[128:131], a[240:243], a[80:83], v[128:131]
    ds_read_b128 a[228:231], v3 offset:9216
    v_mfma_f32_16x16x32_bf16 v[132:135], a[244:247], a[80:83], v[132:135]
    buffer_load_dwordx4 a[108:111], v2, s[32:35], s78 offen offset:3072 sc1
    ds_read_b128 a[232:235], v3 offset:10240
    v_mfma_f32_16x16x32_bf16 v[136:139], a[248:251], a[80:83], v[136:139]
    s_add_u32 s78, s85, 1261568
    ds_read_b128 a[236:239], v3 offset:11264
    v_mfma_f32_16x16x32_bf16 v[140:143], a[252:255], a[80:83], v[140:143]
    s_waitcnt lgkmcnt(4)
    ds_read_b128 a[240:243], v3 offset:12288
    v_mfma_f32_16x16x32_bf16 v[144:147], a[208:211], a[80:83], v[144:147]
    s_waitcnt vmcnt(14) lgkmcnt(4)
    buffer_load_dwordx4 a[112:115], v2, s[32:35], s78 offen offset:0 sc1
    ds_read_b128 a[244:247], v3 offset:13312
    v_mfma_f32_16x16x32_bf16 v[128:131], a[212:215], a[84:87], v[128:131]
    ds_read_b128 a[248:251], v3 offset:14336
    v_mfma_f32_16x16x32_bf16 v[132:135], a[216:219], a[84:87], v[132:135]
    ds_read_b128 a[252:255], v3 offset:15360
    v_mfma_f32_16x16x32_bf16 v[136:139], a[220:223], a[84:87], v[136:139]
    buffer_load_dwordx4 a[116:119], v2, s[32:35], s78 offen offset:1024 sc1
    ds_read_b128 a[208:211], v4 offset:8192
    v_mfma_f32_16x16x32_bf16 v[140:143], a[224:227], a[84:87], v[140:143]
    s_waitcnt lgkmcnt(4)
    s_add_u32 m0, s65, 106496
    ds_read_b128 a[212:215], v4 offset:9216
    v_mfma_f32_16x16x32_bf16 v[144:147], a[228:231], a[84:87], v[144:147]
    s_waitcnt vmcnt(15) lgkmcnt(4)
    s_add_u32 s47, s71, 221184
    ds_read_b128 a[216:219], v4 offset:10240
    v_mfma_f32_16x16x32_bf16 v[128:131], a[232:235], a[88:91], v[128:131]
    buffer_load_dwordx4 v2, s[32:35], s47 offen sc1 lds
    ds_read_b128 a[220:223], v4 offset:11264
    v_mfma_f32_16x16x32_bf16 v[132:135], a[236:239], a[88:91], v[132:135]
    ds_read_b128 a[224:227], v4 offset:12288
    v_mfma_f32_16x16x32_bf16 v[136:139], a[240:243], a[88:91], v[136:139]
    ds_read_b128 a[228:231], v4 offset:13312
    v_mfma_f32_16x16x32_bf16 v[140:143], a[244:247], a[88:91], v[140:143]
    s_waitcnt lgkmcnt(4)
    buffer_load_dwordx4 v2, s[32:35], s47 offen offset:1024 sc1 lds
    ds_read_b128 a[232:235], v4 offset:14336
    v_mfma_f32_16x16x32_bf16 v[144:147], a[248:251], a[88:91], v[144:147]
    s_waitcnt vmcnt(12) lgkmcnt(4)
    s_add_u32 m0, s65, 114688
    ds_read_b128 a[236:239], v4 offset:15360
    v_mfma_f32_16x16x32_bf16 v[128:131], a[252:255], a[92:95], v[128:131]
    s_barrier
    s_add_u32 s47, s71, 229376
    ds_read_b128 a[240:243], v4 offset:16384
    v_mfma_f32_16x16x32_bf16 v[132:135], a[208:211], a[92:95], v[132:135]
    buffer_load_dwordx4 v2, s[32:35], s47 offen sc1 lds
    ds_read_b128 a[244:247], v4 offset:17408
    v_mfma_f32_16x16x32_bf16 v[136:139], a[212:215], a[92:95], v[136:139]
    ds_read_b128 a[248:251], v4 offset:18432
    v_mfma_f32_16x16x32_bf16 v[140:143], a[216:219], a[92:95], v[140:143]
    s_waitcnt lgkmcnt(4)
    ds_read_b128 a[252:255], v4 offset:19456
    v_mfma_f32_16x16x32_bf16 v[144:147], a[220:223], a[92:95], v[144:147]
    s_waitcnt vmcnt(12) lgkmcnt(4)
    buffer_load_dwordx4 v2, s[32:35], s47 offen offset:1024 sc1 lds
    ds_read_b128 a[208:211], v4 offset:20480
    v_mfma_f32_16x16x32_bf16 v[128:131], a[224:227], a[96:99], v[128:131]
    ds_read_b128 a[212:215], v4 offset:21504
    v_mfma_f32_16x16x32_bf16 v[132:135], a[228:231], a[96:99], v[132:135]
    ds_read_b128 a[216:219], v4 offset:22528
    v_mfma_f32_16x16x32_bf16 v[136:139], a[232:235], a[96:99], v[136:139]
    buffer_load_dwordx4 a[120:123], v2, s[32:35], s78 offen offset:2048 sc1
    ds_read_b128 a[220:223], v4 offset:23552
    v_mfma_f32_16x16x32_bf16 v[140:143], a[236:239], a[96:99], v[140:143]
    s_waitcnt lgkmcnt(4)
    ds_read_b128 a[224:227], v3 offset:16384
    v_mfma_f32_16x16x32_bf16 v[144:147], a[240:243], a[96:99], v[144:147]
    s_waitcnt vmcnt(13) lgkmcnt(4)
    buffer_load_dwordx4 a[124:127], v2, s[32:35], s78 offen offset:3072 sc1
    ds_read_b128 a[228:231], v3 offset:17408
    v_mfma_f32_16x16x32_bf16 v[128:131], a[244:247], a[100:103], v[128:131]
    s_add_u32 s78, s85, 1265664
    ds_read_b128 a[232:235], v3 offset:18432
    v_mfma_f32_16x16x32_bf16 v[132:135], a[248:251], a[100:103], v[132:135]
    ds_read_b128 a[236:239], v3 offset:19456
    v_mfma_f32_16x16x32_bf16 v[136:139], a[252:255], a[100:103], v[136:139]
    buffer_load_dwordx4 a[128:131], v2, s[32:35], s78 offen offset:0 sc1
    ds_read_b128 a[240:243], v3 offset:20480
    v_mfma_f32_16x16x32_bf16 v[140:143], a[208:211], a[100:103], v[140:143]
    s_waitcnt lgkmcnt(4)
    s_add_u32 m0, s65, 122880
    ds_read_b128 a[244:247], v3 offset:21504
    v_mfma_f32_16x16x32_bf16 v[144:147], a[212:215], a[100:103], v[144:147]
    s_waitcnt vmcnt(10) lgkmcnt(4)
    s_add_u32 s47, s71, 237568
    ds_read_b128 a[248:251], v3 offset:22528
    v_mfma_f32_16x16x32_bf16 v[128:131], a[216:219], a[104:107], v[128:131]
    buffer_load_dwordx4 v2, s[32:35], s47 offen sc1 lds
    ds_read_b128 a[252:255], v3 offset:23552
    v_mfma_f32_16x16x32_bf16 v[132:135], a[220:223], a[104:107], v[132:135]
    s_barrier
    ds_read_b128 a[208:211], v3 offset:24576
    v_mfma_f32_16x16x32_bf16 v[136:139], a[224:227], a[104:107], v[136:139]
    ds_read_b128 a[212:215], v3 offset:25600
    v_mfma_f32_16x16x32_bf16 v[140:143], a[228:231], a[104:107], v[140:143]
    s_waitcnt lgkmcnt(4)
    buffer_load_dwordx4 v2, s[32:35], s47 offen offset:1024 sc1 lds
    ds_read_b128 a[216:219], v3 offset:26624
    v_mfma_f32_16x16x32_bf16 v[144:147], a[232:235], a[104:107], v[144:147]
    s_waitcnt vmcnt(11) lgkmcnt(4)
    s_add_u32 m0, s65, 131072
    ds_read_b128 a[220:223], v3 offset:27648
    v_mfma_f32_16x16x32_bf16 v[128:131], a[236:239], a[108:111], v[128:131]
    s_add_u32 s47, s71, 245760
    ds_read_b128 a[224:227], v3 offset:28672
    v_mfma_f32_16x16x32_bf16 v[132:135], a[240:243], a[108:111], v[132:135]
    buffer_load_dwordx4 v2, s[32:35], s47 offen sc1 lds
    ds_read_b128 a[228:231], v3 offset:29696
    v_mfma_f32_16x16x32_bf16 v[136:139], a[244:247], a[108:111], v[136:139]
    ds_read_b128 a[232:235], v3 offset:30720
    v_mfma_f32_16x16x32_bf16 v[140:143], a[248:251], a[108:111], v[140:143]
    s_waitcnt lgkmcnt(4)
    ds_read_b128 a[236:239], v3 offset:31744
    v_mfma_f32_16x16x32_bf16 v[144:147], a[252:255], a[108:111], v[144:147]
    s_waitcnt vmcnt(11) lgkmcnt(4)
    buffer_load_dwordx4 v2, s[32:35], s47 offen offset:1024 sc1 lds
    ds_read_b128 a[240:243], v3 offset:32768
    v_mfma_f32_16x16x32_bf16 v[128:131], a[208:211], a[112:115], v[128:131]
    ds_read_b128 a[244:247], v3 offset:33792
    v_mfma_f32_16x16x32_bf16 v[132:135], a[212:215], a[112:115], v[132:135]
    ds_read_b128 a[248:251], v3 offset:34816
    v_mfma_f32_16x16x32_bf16 v[136:139], a[216:219], a[112:115], v[136:139]
    buffer_load_dwordx4 a[132:135], v2, s[32:35], s78 offen offset:1024 sc1
    ds_read_b128 a[252:255], v3 offset:35840
    v_mfma_f32_16x16x32_bf16 v[140:143], a[220:223], a[112:115], v[140:143]
    s_waitcnt lgkmcnt(4)
    ds_read_b128 a[208:211], v3 offset:36864
    v_mfma_f32_16x16x32_bf16 v[144:147], a[224:227], a[112:115], v[144:147]
    s_waitcnt vmcnt(12) lgkmcnt(4)
    ds_read_b128 a[212:215], v3 offset:37888
    v_mfma_f32_16x16x32_bf16 v[128:131], a[228:231], a[116:119], v[128:131]
    buffer_load_dwordx4 a[136:139], v2, s[32:35], s78 offen offset:2048 sc1
    ds_read_b128 a[216:219], v3 offset:38912
    v_mfma_f32_16x16x32_bf16 v[132:135], a[232:235], a[116:119], v[132:135]
    ds_read_b128 a[220:223], v3 offset:39936
    v_mfma_f32_16x16x32_bf16 v[136:139], a[236:239], a[116:119], v[136:139]
    s_waitcnt vmcnt(9)
    s_barrier
    ds_read_b128 a[224:227], v3 offset:40960
    v_mfma_f32_16x16x32_bf16 v[140:143], a[240:243], a[116:119], v[140:143]
    s_waitcnt lgkmcnt(4)
    buffer_load_dwordx4 a[140:143], v2, s[32:35], s78 offen offset:3072 sc1
    ds_read_b128 a[228:231], v3 offset:41984
    v_mfma_f32_16x16x32_bf16 v[144:147], a[244:247], a[116:119], v[144:147]
    s_waitcnt vmcnt(9) lgkmcnt(4)
    s_add_u32 m0, s65, 0
    ds_read_b128 a[232:235], v3 offset:43008
    v_mfma_f32_16x16x32_bf16 v[128:131], a[248:251], a[120:123], v[128:131]
    s_add_u32 s47, s71, 253952
    ds_read_b128 a[236:239], v3 offset:44032
    v_mfma_f32_16x16x32_bf16 v[132:135], a[252:255], a[120:123], v[132:135]
    buffer_load_dwordx4 v2, s[32:35], s47 offen sc1 lds
    ds_read_b128 a[240:243], v3 offset:45056
    v_mfma_f32_16x16x32_bf16 v[136:139], a[208:211], a[120:123], v[136:139]
    ds_read_b128 a[244:247], v3 offset:46080
    v_mfma_f32_16x16x32_bf16 v[140:143], a[212:215], a[120:123], v[140:143]
    s_waitcnt lgkmcnt(4)
    ds_read_b128 a[248:251], v3 offset:47104
    v_mfma_f32_16x16x32_bf16 v[144:147], a[216:219], a[120:123], v[144:147]
    s_waitcnt vmcnt(9) lgkmcnt(4)
    buffer_load_dwordx4 v2, s[32:35], s47 offen offset:1024 sc1 lds
    ds_read_b128 a[252:255], v3 offset:48128
    v_mfma_f32_16x16x32_bf16 v[128:131], a[220:223], a[124:127], v[128:131]
    s_add_u32 m0, s65, 8192
    s_add_u32 s47, s71, 262144
    ds_read_b128 a[208:211], v3 offset:49152
    v_mfma_f32_16x16x32_bf16 v[132:135], a[224:227], a[124:127], v[132:135]
    ds_read_b128 a[212:215], v3 offset:50176
    v_mfma_f32_16x16x32_bf16 v[136:139], a[228:231], a[124:127], v[136:139]
    buffer_load_dwordx4 v2, s[32:35], s47 offen sc1 lds
    ds_read_b128 a[216:219], v3 offset:51200
    v_mfma_f32_16x16x32_bf16 v[140:143], a[232:235], a[124:127], v[140:143]
    s_waitcnt lgkmcnt(4)
    ds_read_b128 a[220:223], v3 offset:52224
    v_mfma_f32_16x16x32_bf16 v[144:147], a[236:239], a[124:127], v[144:147]
    s_waitcnt vmcnt(10) lgkmcnt(4)
    ds_read_b128 a[224:227], v3 offset:53248
    v_mfma_f32_16x16x32_bf16 v[128:131], a[240:243], a[128:131], v[128:131]
    buffer_load_dwordx4 v2, s[32:35], s47 offen offset:1024 sc1 lds
    ds_read_b128 a[228:231], v3 offset:54272
    v_mfma_f32_16x16x32_bf16 v[132:135], a[244:247], a[128:131], v[132:135]
    s_add_u32 s78, s85, 1277952
    ds_read_b128 a[232:235], v3 offset:55296
    v_mfma_f32_16x16x32_bf16 v[136:139], a[248:251], a[128:131], v[136:139]
    ds_read_b128 a[236:239], v3 offset:56320
    v_mfma_f32_16x16x32_bf16 v[140:143], a[252:255], a[128:131], v[140:143]
    s_waitcnt lgkmcnt(4)
    s_waitcnt vmcnt(7)
    s_barrier
    buffer_load_dwordx4 a[144:147], v2, s[32:35], s78 offen offset:0 sc1
    v_mfma_f32_16x16x32_bf16 v[144:147], a[208:211], a[128:131], v[144:147]
    s_waitcnt vmcnt(7) lgkmcnt(3)
    ds_read_b128 a[240:243], v3 offset:57344
    ds_read_b128 a[244:247], v3 offset:58368
    v_mfma_f32_16x16x32_bf16 v[128:131], a[212:215], a[132:135], v[128:131]
    ds_read_b128 a[248:251], v3 offset:59392
    v_mfma_f32_16x16x32_bf16 v[132:135], a[216:219], a[132:135], v[132:135]
    buffer_load_dwordx4 a[148:151], v2, s[32:35], s78 offen offset:1024 sc1
    ds_read_b128 a[252:255], v3 offset:60416
    v_mfma_f32_16x16x32_bf16 v[136:139], a[220:223], a[132:135], v[136:139]
    ds_read_b128 a[208:211], v3 offset:61440
    v_mfma_f32_16x16x32_bf16 v[140:143], a[224:227], a[132:135], v[140:143]
    s_waitcnt lgkmcnt(5)
    ds_read_b128 a[212:215], v3 offset:62464
    v_mfma_f32_16x16x32_bf16 v[144:147], a[228:231], a[132:135], v[144:147]
    s_waitcnt vmcnt(7) lgkmcnt(4)
    buffer_load_dwordx4 a[152:155], v2, s[32:35], s78 offen offset:2048 sc1
    ds_read_b128 a[216:219], v3 offset:63488
    v_mfma_f32_16x16x32_bf16 v[128:131], a[232:235], a[136:139], v[128:131]
    s_add_u32 m0, s65, 16384
    s_add_u32 s47, s71, 270336
    ds_read_b128 a[220:223], v3 offset:64512
    v_mfma_f32_16x16x32_bf16 v[132:135], a[236:239], a[136:139], v[132:135]
    ds_read_b128 a[224:227], v4 offset:0
    v_mfma_f32_16x16x32_bf16 v[136:139], a[240:243], a[136:139], v[136:139]
    buffer_load_dwordx4 v10, s[32:35], s47 offen sc1 lds
    ds_read_b128 a[228:231], v4 offset:1024
    v_mfma_f32_16x16x32_bf16 v[140:143], a[244:247], a[136:139], v[140:143]
    s_waitcnt lgkmcnt(4)
    ds_read_b128 a[232:235], v4 offset:2048
    v_mfma_f32_16x16x32_bf16 v[144:147], a[248:251], a[136:139], v[144:147]
    s_waitcnt vmcnt(8) lgkmcnt(4)
    ds_read_b128 a[236:239], v4 offset:3072
    v_mfma_f32_16x16x32_bf16 v[128:131], a[252:255], a[140:143], v[128:131]
    buffer_load_dwordx4 v10, s[32:35], s47 offen offset:1024 sc1 lds
    ds_read_b128 a[240:243], v4 offset:4096
    v_mfma_f32_16x16x32_bf16 v[132:135], a[208:211], a[140:143], v[132:135]
    ds_read_b128 a[244:247], v4 offset:5120
    v_mfma_f32_16x16x32_bf16 v[136:139], a[212:215], a[140:143], v[136:139]
    ds_read_b128 a[248:251], v4 offset:6144
    v_mfma_f32_16x16x32_bf16 v[140:143], a[216:219], a[140:143], v[140:143]
    s_waitcnt lgkmcnt(4)
    buffer_load_dwordx4 a[156:159], v2, s[32:35], s78 offen offset:3072 sc1
    ds_read_b128 a[252:255], v4 offset:7168
    v_mfma_f32_16x16x32_bf16 v[144:147], a[220:223], a[140:143], v[144:147]
    s_waitcnt vmcnt(5) lgkmcnt(4)
    s_barrier
    ds_read_b128 a[208:211], v2 offset:0
    v_mfma_f32_16x16x32_bf16 v[128:131], a[224:227], a[144:147], v[128:131]
    s_add_u32 s78, s85, 1282048
    ds_read_b128 a[212:215], v2 offset:1024
    v_mfma_f32_16x16x32_bf16 v[132:135], a[228:231], a[144:147], v[132:135]
    buffer_load_dwordx4 a[160:163], v2, s[32:35], s78 offen offset:0 sc1
    ds_read_b128 a[216:219], v2 offset:2048
    v_mfma_f32_16x16x32_bf16 v[136:139], a[232:235], a[144:147], v[136:139]
    ds_read_b128 a[220:223], v2 offset:3072
    v_mfma_f32_16x16x32_bf16 v[140:143], a[236:239], a[144:147], v[140:143]
    s_waitcnt lgkmcnt(4)
    ds_read_b128 a[224:227], v2 offset:4096
    v_mfma_f32_16x16x32_bf16 v[144:147], a[240:243], a[144:147], v[144:147]
    s_waitcnt vmcnt(5) lgkmcnt(4)
    buffer_load_dwordx4 a[164:167], v2, s[32:35], s78 offen offset:1024 sc1
    ds_read_b128 a[228:231], v2 offset:5120
    v_mfma_f32_16x16x32_bf16 v[128:131], a[244:247], a[148:151], v[128:131]
    ds_read_b128 a[232:235], v2 offset:6144
    v_mfma_f32_16x16x32_bf16 v[132:135], a[248:251], a[148:151], v[132:135]
    ds_read_b128 a[236:239], v2 offset:7168
    v_mfma_f32_16x16x32_bf16 v[136:139], a[252:255], a[148:151], v[136:139]
    ds_read_b128 a[240:243], v2 offset:8192
    v_mfma_f32_16x16x32_bf16 v[140:143], a[208:211], a[148:151], v[140:143]
    s_waitcnt lgkmcnt(4)
    ds_read_b128 a[244:247], v2 offset:9216
    v_mfma_f32_16x16x32_bf16 v[144:147], a[212:215], a[148:151], v[144:147]
    s_waitcnt vmcnt(5) lgkmcnt(4)
    ds_read_b128 a[248:251], v2 offset:10240
    v_mfma_f32_16x16x32_bf16 v[128:131], a[216:219], a[152:155], v[128:131]
    ds_read_b128 a[252:255], v2 offset:11264
    v_mfma_f32_16x16x32_bf16 v[132:135], a[220:223], a[152:155], v[132:135]
    ds_read_b128 a[208:211], v2 offset:12288
    v_mfma_f32_16x16x32_bf16 v[136:139], a[224:227], a[152:155], v[136:139]
    ds_read_b128 a[212:215], v2 offset:13312
    v_mfma_f32_16x16x32_bf16 v[140:143], a[228:231], a[152:155], v[140:143]
    s_waitcnt lgkmcnt(4)
    ds_read_b128 a[216:219], v2 offset:14336
    v_mfma_f32_16x16x32_bf16 v[144:147], a[232:235], a[152:155], v[144:147]
L_pad8:
    s_cbranch_execz L_hopped
    s_waitcnt vmcnt(2) lgkmcnt(4)
    ds_read_b128 a[220:223], v2 offset:15360
    v_mfma_f32_16x16x32_bf16 v[128:131], a[236:239], a[156:159], v[128:131]
    s_barrier
    ds_read_b128 a[224:227], v2 offset:16384
    v_mfma_f32_16x16x32_bf16 v[132:135], a[240:243], a[156:159], v[132:135]
    ds_read_b128 a[228:231], v2 offset:17408
    v_mfma_f32_16x16x32_bf16 v[136:139], a[244:247], a[156:159], v[136:139]
    ds_read_b128 a[232:235], v2 offset:18432
    v_mfma_f32_16x16x32_bf16 v[140:143], a[248:251], a[156:159], v[140:143]
    s_waitcnt lgkmcnt(4)
    ds_read_b128 a[236:239], v2 offset:19456
    v_mfma_f32_16x16x32_bf16 v[144:147], a[252:255], a[156:159], v[144:147]
    s_waitcnt vmcnt(1) lgkmcnt(4)
    ds_read_b128 a[240:243], v2 offset:20480
    v_mfma_f32_16x16x32_bf16 v[128:131], a[208:211], a[160:163], v[128:131]
    ds_read_b128 a[244:247], v2 offset:21504
    v_mfma_f32_16x16x32_bf16 v[132:135], a[212:215], a[160:163], v[132:135]
    v_mfma_f32_16x16x32_bf16 v[136:139], a[216:219], a[160:163], v[136:139]
    v_mfma_f32_16x16x32_bf16 v[140:143], a[220:223], a[160:163], v[140:143]
    s_waitcnt lgkmcnt(2)
    v_mfma_f32_16x16x32_bf16 v[144:147], a[224:227], a[160:163], v[144:147]
    s_waitcnt vmcnt(0) lgkmcnt(1)
    v_mfma_f32_16x16x32_bf16 v[128:131], a[228:231], a[164:167], v[128:131]
    v_mfma_f32_16x16x32_bf16 v[132:135], a[232:235], a[164:167], v[132:135]
    v_mfma_f32_16x16x32_bf16 v[136:139], a[236:239], a[164:167], v[136:139]
    v_mfma_f32_16x16x32_bf16 v[140:143], a[240:243], a[164:167], v[140:143]
    s_waitcnt lgkmcnt(0)
    v_mfma_f32_16x16x32_bf16 v[144:147], a[244:247], a[164:167], v[144:147]
    s_nop 2
    v_pk_fma_f32 v[128:129], v[128:129], v[64:65], v[104:105]
    v_cvt_pk_bf16_f32 v32, v128, v129
    v_pk_fma_f32 v[130:131], v[130:131], v[66:67], v[106:107]
    v_cvt_pk_bf16_f32 v33, v130, v131
    v_pk_fma_f32 v[132:133], v[132:133], v[68:69], v[108:109]
    v_cvt_pk_bf16_f32 v34, v132, v133
    v_pk_fma_f32 v[134:135], v[134:135], v[70:71], v[110:111]
    v_cvt_pk_bf16_f32 v35, v134, v135
    buffer_store_dwordx4 v[32:35], v28, s[36:39], s80 offen
    v_pk_fma_f32 v[136:137], v[136:137], v[72:73], v[112:113]
    v_cvt_pk_bf16_f32 v36, v136, v137
    v_pk_fma_f32 v[138:139], v[138:139], v[74:75], v[114:115]
    v_cvt_pk_bf16_f32 v37, v138, v139
    v_pk_fma_f32 v[140:141], v[140:141], v[76:77], v[116:117]
    v_cvt_pk_bf16_f32 v38, v140, v141
    v_pk_fma_f32 v[142:143], v[142:143], v[78:79], v[118:119]
    v_cvt_pk_bf16_f32 v39, v142, v143
    buffer_store_dwordx4 v[36:39], v28, s[36:39], s80 offen offset:64
    v_pk_fma_f32 v[144:145], v[144:145], v[80:81], v[120:121]
    v_cvt_pk_bf16_f32 v40, v144, v145
    v_pk_fma_f32 v[146:147], v[146:147], v[82:83], v[122:123]
    v_cvt_pk_bf16_f32 v41, v146, v147
    v_cmp_gt_u32 vcc, 32, v1
    v_permlane32_swap_b32 v40, v42
    v_permlane32_swap_b32 v41, v43
    v_cndmask_b32 v28, v61, v28, vcc
    buffer_store_dwordx4 v[40:43], v28, s[36:39], s80 offen offset:128
    s_add_u32 s76, s2, s60
    s_cmp_lg_u32 s76, 0
    s_cbranch_scc1 L_noepoch_40
    v_lshlrev_b32 v23, 7, v1
    v_subrev_u32 v56, s64, v56
    v_subrev_u32 v57, s64, v57
    v_subrev_u32 v58, s64, v58
    v_subrev_u32 v59, s64, v59
    v_max3_u32 v56, v56, v57, v58
    v_max_u32 v56, v56, v59
    v_cmp_lt_u32 vcc, 7, v56
    s_nop 0
    s_cbranch_vccz L_epoch_41
    s_mov_b32 s67, 0
L_poll_42:
    s_mov_b32 s76, 360448
    buffer_load_dword v56, v23, s[32:35], s76 offen sc1
    s_mov_b32 s76, 368640
    buffer_load_dword v57, v23, s[32:35], s76 offen sc1
    s_mov_b32 s76, 376832
    buffer_load_dword v58, v23, s[32:35], s76 offen sc1
    s_mov_b32 s76, 385024
    buffer_load_dword v59, v23, s[32:35], s76 offen sc1
    s_waitcnt vmcnt(0)
    v_subrev_u32 v56, s64, v56
    v_subrev_u32 v57, s64, v57
    v_subrev_u32 v58, s64, v58
    v_subrev_u32 v59, s64, v59
    v_max_u32 v56, v56, v57
    v_max_u32 v56, v56, v58
    v_max_u32 v56, v56, v59
    v_cmp_lt_u32 vcc, 7, v56
    s_nop 0
    s_cbranch_vccz L_ready_43
    s_add_u32 s67, s67, 1
    s_cmp_lt_u32 s67, 20000
    s_cbranch_scc1 L_poll_42
L_ready_43:
L_epoch_41:
    v_mov_b32 v56, s64
    v_lshlrev_b32 v57, 2, v1
    buffer_store_dword v56, v57, s[32:35], 0 offen sc1
L_noepoch_40:
L_end:
    s_endpgm
.fill 8192, 4, 0xbf800000
.section .rodata,"a"
.p2align 6
.amdhsa_kernel adaLN_cond__sliding_local_dilated__glu_gated_bilinear__prompt_kernel
  .amdhsa_next_free_vgpr 512
  .amdhsa_next_free_sgpr 102
  .amdhsa_accum_offset 256
  .amdhsa_group_segment_fixed_size 0
  .amdhsa_kernarg_size 96
  .amdhsa_user_sgpr_count 2
  .amdhsa_user_sgpr_kernarg_segment_ptr 1
  .amdhsa_system_sgpr_workgroup_id_x 1
  .amdhsa_float_denorm_mode_32 3
.end_amdhsa_kernel
```
